```python
import torch

def _softmax(x, axis=-1):
    return torch.softmax(x, dim=axis)
def _gelu(x):
    return torch.nn.functional.gelu(x, approximate="tanh")
def _silu(x):
    return torch.nn.functional.silu(x)
def _sigmoid(x):
    return torch.sigmoid(x)
def _layernorm(x, axis=-1, eps=1e-5):
    m = x.mean(dim=axis, keepdim=True)
    v = x.var(dim=axis, keepdim=True, unbiased=False)
    return (x - m) / torch.sqrt(v + eps)
def _scatter_add(tgt, idx, src, axis=0):
    return tgt.clone().index_add_(axis, idx, src)
def _segment_sum(src, seg, n):
    out = torch.zeros((n,) + src.shape[1:], dtype=src.dtype)
    return out.index_add_(0, seg, src)
def _pad(x, pw):
    flat = tuple(v for pair in reversed(pw) for v in pair)
    return torch.nn.functional.pad(x, flat)

kernel_name = 'sequential_preLN__ssm_conv_h3__dense_activation_gelu__prompt'

def setup_inputs():

    _w = (lambda a: (lambda t: t.to(torch.bfloat16) if t.is_floating_point() else t)(torch.as_tensor(a)))
    def _A_setup():
        B, S, D = 1, 2048, 448
        ks = 4
        return {
            "q": _w((lambda *s: torch.randn(*s, dtype=torch.bfloat16) * 0.05)(B, S, D)),
            "k": _w((lambda *s: torch.randn(*s, dtype=torch.bfloat16) * 0.2)(B, S, D)),
            "v": _w((lambda *s: torch.randn(*s, dtype=torch.bfloat16) * 0.2)(B, S, D)),
            "shift_k": _w((lambda *s: torch.randn(*s, dtype=torch.bfloat16) * 0.2)(D, ks) * 0.5),
            "ssm_k": _w((lambda *s: torch.randn(*s, dtype=torch.bfloat16) * 0.4)(D, S) * (1.0 / S ** 0.5)),
            "ssm_D": _w((lambda *s: torch.randn(*s, dtype=torch.bfloat16) * 0.2)(D)),
        }
    _A_in = _A_setup()

    def _B_setup():
        B, S, D, F = 1, 2048, 448, 1792
        return {
            "x": _w((lambda *s: torch.randn(*s, dtype=torch.bfloat16) * 0.05)(B, S, D)),
            "w1": _w((lambda *s: torch.randn(*s, dtype=torch.bfloat16) * 0.4)(D, F) * (D ** -0.5)),
            "b1": _w((lambda *s: torch.randn(*s, dtype=torch.bfloat16) * 12.8)(F) * 0.01),
            "w2": _w((lambda *s: torch.randn(*s, dtype=torch.bfloat16) * 0.2)(F, D) * (F ** -0.5)),
            "b2": _w((lambda *s: torch.randn(*s, dtype=torch.bfloat16) * 1.6)(D) * 0.01),
        }
    _B_in = _B_setup()

    return {
        "A_q": _A_in["q"],
        "A_k": _A_in["k"],
        "A_v": _A_in["v"],
        "A_shift_k": _A_in["shift_k"],
        "A_ssm_k": _A_in["ssm_k"],
        "A_ssm_D": _A_in["ssm_D"],
        "B_x": _B_in["x"],
        "B_w1": _B_in["w1"],
        "B_b1": _B_in["b1"],
        "B_w2": _B_in["w2"],
        "B_b2": _B_in["b2"],
    }

def reference(A_q, A_k, A_v, A_shift_k, A_ssm_k, A_ssm_D, B_x, B_w1, B_b1, B_w2, B_b2):
    def _A_ref(q, k, v, shift_k, ssm_k, ssm_D):
        B, S, D = q.shape
        ks = shift_k.shape[-1]
        k_pad = _pad(k, ((0, 0), (ks - 1, 0), (0, 0)))
        k_shift = torch.zeros_like(k)
        for t in range(ks):
            k_shift = k_shift + k_pad[:, t:t + S, :] * shift_k[:, ks - 1 - t][None, None, :]
        kv = k_shift * v
        L = 2 * S
        kv_pad = _pad(kv, ((0, 0), (0, S), (0, 0)))
        kf_pad = _pad(ssm_k, ((0, 0), (0, S)))
        kv_f = (lambda x, axes=(-2,-1): torch.fft.rfft2(x.float(), dim=axes))(kv_pad[:, None, :, :], axes=(1, 2))
        kf_f = (lambda x, axes=(-2,-1): torch.fft.rfft2(x.float(), dim=axes))(kf_pad[:, None, :], axes=(1, 2))
        kf_f = (lambda x, *d: x.permute(*d))(kf_f, 1, 2, 0)
        y_f = kv_f * kf_f[None, :, :, :]
        y = (lambda x, s, axes=(-2,-1): torch.fft.irfft2(x, s=s, dim=axes).to(torch.bfloat16))(y_f, (1, L), axes=(1, 2))[:, 0, :S, :]
        y = y + kv * ssm_D[None, None, :]
        return q * y

    def _B_ref(x, w1, b1, w2, b2):
        h = torch.einsum("bsd,df->bsf", x, w1) + b1
        h = _gelu(h)
        return torch.einsum("bsf,fd->bsd", h, w2) + b2

    x = A_q
    h = x + _A_ref(_layernorm(x, axis=-1), A_k, A_v, A_shift_k, A_ssm_k, A_ssm_D)
    h2 = h + _B_ref(_layernorm(h, axis=-1), B_w1, B_b1, B_w2, B_b2)
    return h2
```

```asm
; @launch grid=(233,1,1) block=(256,1,1) lds=163840
.amdgcn_target "amdgcn-amd-amdhsa--gfx950"
.text
.globl sequential_preLN__ssm_conv_h3__dense_activation_gelu__prompt_kernel
.p2align 8
.type sequential_preLN__ssm_conv_h3__dense_activation_gelu__prompt_kernel,@function
sequential_preLN__ssm_conv_h3__dense_activation_gelu__prompt_kernel:
    s_load_dwordx16 s[8:23], s[0:1], 0
    s_getpc_b64 s[88:89]
L_PC:
    s_load_dwordx8 s[24:31], s[0:1], 64
    s_load_dwordx4 s[32:35], s[0:1], 96
    s_cmp_ge_u32 s2, 224
    s_cbranch_scc1 L_OTHER
    s_lshr_b32 s42, s2, 5
    s_and_b32 s43, s2, 31
    v_lshrrev_b32 v2, 3, v0
    v_and_b32 v3, 7, v0
    s_mul_i32 s66, s43, 57344
    s_lshl_b32 s67, s42, 7
    s_add_u32 s66, s66, s67
    v_mul_u32_u24 v4, 1792, v2
    v_lshl_add_u32 v4, v3, 4, v4
    v_add_u32 v7, s66, v4
    v_subrev_u32 v92, 2688, v7
    v_subrev_u32 v93, 1792, v7
    v_subrev_u32 v94, 896, v7
    s_lshl_b32 s67, s42, 9
    v_lshl_add_u32 v8, v3, 6, s67
    s_mov_b32 s46, 1835008
    s_mov_b32 s47, 0x20000
    s_waitcnt lgkmcnt(0)
    s_mov_b32 s44, s10
    s_mov_b32 s45, s11
    buffer_load_dwordx4 v[10:13], v92, s[44:47], 0 offen
    buffer_load_dwordx4 v[14:17], v93, s[44:47], 0 offen
    buffer_load_dwordx4 v[18:21], v94, s[44:47], 0 offen
    buffer_load_dwordx4 v[22:25], v7, s[44:47], 0 offen
    buffer_load_dwordx4 v[26:29], v7, s[44:47], 0 offen offset:896
    global_load_dwordx4 v[30:33], v7, s[12:13]
    global_load_dwordx4 v[34:37], v7, s[12:13] offset:896
    global_load_dwordx4 v[46:49], v8, s[14:15]
    global_load_dwordx4 v[50:53], v8, s[14:15] offset:16
    global_load_dwordx4 v[54:57], v8, s[14:15] offset:32
    global_load_dwordx4 v[58:61], v8, s[14:15] offset:48
    global_load_dwordx4 v[38:41], v7, s[8:9]
    global_load_dwordx4 v[42:45], v7, s[8:9] offset:896
    v_and_b32 v1, 63, v0
    v_lshrrev_b32 v5, 6, v0
    s_mov_b32 s70, 0x05040100
    s_mov_b32 s71, 0x07060302
    v_readfirstlane_b32 s3, v5
    s_mov_b32 s72, 0xffff0000
    s_mov_b32 s73, 0x3f803f80
    s_lshr_b32 s37, s2, 3
    s_lshr_b32 s66, s2, 1
    s_mul_i32 s66, s66, 14336
    s_and_b32 s67, s2, 1
    s_mul_i32 s67, s67, 448
    s_add_u32 s66, s66, s67
    s_mov_b32 s67, 2341
    v_mul_lo_u32 v110, v0, s67
    v_lshrrev_b32 v110, 16, v110
    v_mul_u32_u24 v111, 28, v110
    v_sub_u32 v111, v0, v111
    v_mul_u32_u24 v110, 896, v110
    v_lshl_add_u32 v110, v111, 4, v110
    v_add_u32 v110, s66, v110
    v_add_u32 v112, 256, v0
    v_mul_lo_u32 v113, v112, s67
    v_lshrrev_b32 v113, 16, v113
    v_mul_u32_u24 v111, 28, v113
    v_sub_u32 v111, v112, v111
    v_mul_u32_u24 v113, 896, v113
    v_lshl_add_u32 v113, v111, 4, v113
    v_add_u32 v113, s66, v113
    s_lshl_b32 s66, s37, 10
    s_min_u32 s66, s66, L_CODE_END-sequential_preLN__ssm_conv_h3__dense_activation_gelu__prompt_kernel-1024
    v_lshl_add_u32 v114, v1, 4, s66
    s_lshl_b32 s69, s3, 10
    s_add_u32 m0, s69, 0
    s_nop 0
    global_load_lds_dwordx4 v110, s[26:27]
    s_cmp_eq_u32 s3, 3
    s_cbranch_scc1 x3_1
    s_add_u32 m0, m0, 4096
    s_nop 0
    global_load_lds_dwordx4 v113, s[26:27]
    s_branch xd_2
x3_1:
    s_sub_u32 s88, s88, L_PC-sequential_preLN__ssm_conv_h3__dense_activation_gelu__prompt_kernel
    s_subb_u32 s89, s89, 0
    global_load_dwordx4 v[116:119], v114, s[88:89]
xd_2:
    s_mov_b32 s76, 0
    s_cmp_lt_u32 s3, 2
    s_cbranch_scc1 nost_3
    s_mov_b32 s48, s16
    s_mov_b32 s49, s17
    s_mov_b32 s50, 1835008
    s_mov_b32 s51, 0x20000
    v_lshlrev_b32 v115, 4, v1
    s_sub_u32 s66, s3, 2
    s_lshl_b32 s67, s2, 1
    s_add_u32 s67, s67, s66
    s_lshl_b32 s67, s67, 12
    s_load_dword s77, s[16:17], s67
    s_mul_i32 s66, s66, 8320
    s_add_u32 m0, s66, 131136
    s_add_u32 s79, s66, 135292
    s_nop 0
    buffer_load_dwordx4 v115, s[48:51], s67 offen lds
    s_add_u32 m0, m0, 1024
    s_add_u32 s67, s67, 1024
    s_nop 0
    buffer_load_dwordx4 v115, s[48:51], s67 offen lds
    s_add_u32 m0, m0, 1024
    s_add_u32 s67, s67, 1024
    s_nop 0
    buffer_load_dwordx4 v115, s[48:51], s67 offen lds
    s_add_u32 m0, m0, 1024
    s_add_u32 s67, s67, 1024
    s_nop 0
    buffer_load_dwordx4 v115, s[48:51], s67 offen lds
    s_add_u32 m0, m0, 1024
    s_add_u32 s67, s67, 1024
    s_add_u32 m0, m0, 64
    s_sub_u32 s67, s67, 4094
    s_nop 0
    buffer_load_dwordx4 v115, s[48:51], s67 offen lds
    s_add_u32 m0, m0, 1024
    s_add_u32 s67, s67, 1024
    s_nop 0
    buffer_load_dwordx4 v115, s[48:51], s67 offen lds
    s_add_u32 m0, m0, 1024
    s_add_u32 s67, s67, 1024
    s_nop 0
    buffer_load_dwordx4 v115, s[48:51], s67 offen lds
    s_add_u32 m0, m0, 1024
    s_add_u32 s67, s67, 1024
    s_nop 0
    buffer_load_dwordx4 v115, s[48:51], s67 offen lds
    s_add_u32 m0, m0, 1024
    s_add_u32 s67, s67, 1024
    s_cmp_lt_u32 s42, 4
    s_cbranch_scc0 nost_3
    s_mov_b32 s76, 1
    s_lshl_b32 s66, s43, 6
    s_lshl_b32 s67, s42, 4
    s_add_u32 s66, s66, s67
    s_sub_u32 s67, s3, 2
    s_lshl_b32 s67, s67, 3
    s_add_u32 s66, s66, s67
    v_lshrrev_b32 v120, 3, v1
    v_add_u32 v120, s66, v120
    v_mul_u32_u24 v121, 896, v120
    v_and_b32 v122, 7, v1
    v_lshl_add_u32 v121, v122, 4, v121
    global_load_dwordx4 v[64:67], v121, s[8:9] offset:0
    global_load_dwordx4 v[68:71], v121, s[8:9] offset:128
    global_load_dwordx4 v[72:75], v121, s[8:9] offset:256
    global_load_dwordx4 v[76:79], v121, s[8:9] offset:384
    global_load_dwordx4 v[80:83], v121, s[8:9] offset:512
    global_load_dwordx4 v[84:87], v121, s[8:9] offset:640
    global_load_dwordx4 v[88:91], v121, s[8:9] offset:768
nost_3:
    s_add_u32 s52, s34, 1048576
    s_addc_u32 s53, s35, 0
    s_add_u32 s54, s34, 3145728
    s_addc_u32 s55, s35, 0
    s_add_u32 s56, s34, 5242880
    s_addc_u32 s57, s35, 0
    s_add_u32 s58, s34, 7340032
    s_addc_u32 s59, s35, 0
    s_add_u32 s60, s34, 10485760
    s_addc_u32 s61, s35, 0
    s_add_u32 s62, s34, 8388608
    s_addc_u32 s63, s35, 0
    v_sub_u32 v96, 31, v2
    v_lshrrev_b32 v97, 2, v96
    v_xor_b32 v97, v97, v3
    v_lshlrev_b32 v97, 4, v97
    v_and_b32 v96, 3, v96
    v_lshl_add_u32 v97, v96, 2, v97
    v_lshl_add_u32 v95, v3, 10, v97
    v_add_u32 v95, 114688, v95
    v_lshrrev_b32 v96, 1, v2
    v_xor_b32 v96, v96, v3
    v_lshlrev_b32 v96, 4, v96
    v_and_b32 v97, 1, v2
    v_lshl_add_u32 v96, v97, 3, v96
    v_lshl_add_u32 v96, v3, 10, v96
    v_add_u32 v96, 122880, v96
    v_lshrrev_b32 v98, 6, v0
    v_xor_b32 v99, v3, v98
    v_lshlrev_b32 v99, 4, v99
    v_lshl_add_u32 v100, v2, 7, v99
    v_add_u32 v100, 114688, v100
    s_lshl_b32 s66, s42, 18
    s_sub_u32 s67, 31, s43
    s_lshl_b32 s67, s67, 7
    s_add_u32 s66, s66, s67
    v_lshlrev_b32 v102, 12, v2
    v_lshl_add_u32 v102, v3, 4, v102
    v_add_u32 v102, s66, v102
    v_and_b32 v104, 15, v0
    v_lshrrev_b32 v105, 4, v0
    v_xor_b32 v106, v104, v98
    v_lshlrev_b32 v106, 4, v106
    v_lshl_add_u32 v106, v105, 8, v106
    v_add_u32 v106, 122880, v106
    s_lshl_b32 s66, s42, 18
    s_lshl_b32 s67, s43, 8
    s_add_u32 s66, s66, s67
    v_lshlrev_b32 v108, 13, v105
    v_lshl_add_u32 v108, v104, 4, v108
    v_add_u32 v108, s66, v108
    v_mov_b32 v101, 161280
    v_mov_b32 v103, 0
    ds_write2_b32 v101, v103, v103 offset1:1
    v_lshrrev_b32 v123, 5, v1
    v_bfe_u32 v124, v1, 2, 2
    v_lshl_add_u32 v123, v123, 2, v124
    v_mul_u32_u24 v123, 448, v123
    v_bfe_u32 v124, v1, 4, 1
    v_lshl_add_u32 v123, v124, 5, v123
    v_and_b32 v124, 3, v1
    v_lshl_add_u32 v123, v124, 3, v123
    s_lshl_b32 s66, s3, 6
    s_add_u32 s66, s66, 0
    v_add_u32 v123, s66, v123
    s_and_b32 s66, s2, 1
    s_mul_i32 s66, s66, 7
    s_add_u32 s66, s66, s3
    s_mul_i32 s66, s66, 112
    s_lshr_b32 s67, s2, 1
    s_add_u32 s66, s66, s67
    s_lshl_b32 s66, s66, 10
    v_lshl_add_u32 v124, v1, 4, s66
    s_and_b32 s36, s2, 7
    s_mul_i32 s66, s37, 37
    s_lshr_b32 s66, s66, 8
    s_mul_i32 s67, s66, 7
    s_sub_u32 s41, s37, s67
    s_lshl_b32 s40, s36, 2
    s_add_u32 s40, s40, s66
    s_lshr_b32 s80, s40, 1
    s_lshr_b32 s38, s36, 1
    s_lshl_b32 s38, s38, 2
    s_add_u32 s38, s38, s66
    s_and_b32 s39, s36, 1
    s_mul_i32 s39, s39, 7
    s_add_u32 s39, s39, s41
    s_cmp_ge_u32 s3, 2
    s_cbranch_scc1 wc_6
    s_waitcnt vmcnt(4)
    s_branch wb_5
wc_6:
    s_cmp_eq_u32 s76, 0
    s_cbranch_scc1 wa_4
    s_waitcnt vmcnt(19)
    s_branch wb_5
wa_4:
    s_waitcnt vmcnt(12)
wb_5:
    v_perm_b32 v126, v18, v22, s70
    v_perm_b32 v134, v18, v22, s71
    v_perm_b32 v127, v10, v14, s70
    v_perm_b32 v135, v10, v14, s71
    v_perm_b32 v128, v22, v26, s70
    v_perm_b32 v136, v22, v26, s71
    v_perm_b32 v129, v14, v18, s70
    v_perm_b32 v137, v14, v18, s71
    v_dot2_f32_bf16 v130, v126, v46, 0
    v_dot2_f32_bf16 v138, v134, v48, 0
    v_dot2_f32_bf16 v131, v128, v46, 0
    v_dot2_f32_bf16 v139, v136, v48, 0
    v_dot2_f32_bf16 v130, v127, v47, v130
    v_dot2_f32_bf16 v138, v135, v49, v138
    v_dot2_f32_bf16 v131, v129, v47, v131
    v_dot2_f32_bf16 v139, v137, v49, v139
    v_lshlrev_b32 v132, 16, v30
    v_and_b32 v140, s72, v30
    v_lshlrev_b32 v133, 16, v34
    v_and_b32 v141, s72, v34
    v_mul_f32 v130, v130, v132
    v_mul_f32 v138, v138, v140
    v_mul_f32 v131, v131, v133
    v_mul_f32 v139, v139, v141
    v_cvt_pk_bf16_f32 v130, v131, v130
    v_cvt_pk_bf16_f32 v138, v139, v138
    ds_write_b32 v95, v130 offset:0
    ds_write_b32 v95, v138 offset:128
    v_perm_b32 v126, v19, v23, s70
    v_perm_b32 v134, v19, v23, s71
    v_perm_b32 v127, v11, v15, s70
    v_perm_b32 v135, v11, v15, s71
    v_perm_b32 v128, v23, v27, s70
    v_perm_b32 v136, v23, v27, s71
    v_perm_b32 v129, v15, v19, s70
    v_perm_b32 v137, v15, v19, s71
    v_dot2_f32_bf16 v130, v126, v50, 0
    v_dot2_f32_bf16 v138, v134, v52, 0
    v_dot2_f32_bf16 v131, v128, v50, 0
    v_dot2_f32_bf16 v139, v136, v52, 0
    v_dot2_f32_bf16 v130, v127, v51, v130
    v_dot2_f32_bf16 v138, v135, v53, v138
    v_dot2_f32_bf16 v131, v129, v51, v131
    v_dot2_f32_bf16 v139, v137, v53, v139
    v_lshlrev_b32 v132, 16, v31
    v_and_b32 v140, s72, v31
    v_lshlrev_b32 v133, 16, v35
    v_and_b32 v141, s72, v35
    v_mul_f32 v130, v130, v132
    v_mul_f32 v138, v138, v140
    v_mul_f32 v131, v131, v133
    v_mul_f32 v139, v139, v141
    v_cvt_pk_bf16_f32 v130, v131, v130
    v_cvt_pk_bf16_f32 v138, v139, v138
    ds_write_b32 v95, v130 offset:256
    ds_write_b32 v95, v138 offset:384
    v_perm_b32 v126, v20, v24, s70
    v_perm_b32 v134, v20, v24, s71
    v_perm_b32 v127, v12, v16, s70
    v_perm_b32 v135, v12, v16, s71
    v_perm_b32 v128, v24, v28, s70
    v_perm_b32 v136, v24, v28, s71
    v_perm_b32 v129, v16, v20, s70
    v_perm_b32 v137, v16, v20, s71
    v_dot2_f32_bf16 v130, v126, v54, 0
    v_dot2_f32_bf16 v138, v134, v56, 0
    v_dot2_f32_bf16 v131, v128, v54, 0
    v_dot2_f32_bf16 v139, v136, v56, 0
    v_dot2_f32_bf16 v130, v127, v55, v130
    v_dot2_f32_bf16 v138, v135, v57, v138
    v_dot2_f32_bf16 v131, v129, v55, v131
    v_dot2_f32_bf16 v139, v137, v57, v139
    v_lshlrev_b32 v132, 16, v32
    v_and_b32 v140, s72, v32
    v_lshlrev_b32 v133, 16, v36
    v_and_b32 v141, s72, v36
    v_mul_f32 v130, v130, v132
    v_mul_f32 v138, v138, v140
    v_mul_f32 v131, v131, v133
    v_mul_f32 v139, v139, v141
    v_cvt_pk_bf16_f32 v130, v131, v130
    v_cvt_pk_bf16_f32 v138, v139, v138
    ds_write_b32 v95, v130 offset:512
    ds_write_b32 v95, v138 offset:640
    v_perm_b32 v126, v21, v25, s70
    v_perm_b32 v134, v21, v25, s71
    v_perm_b32 v127, v13, v17, s70
    v_perm_b32 v135, v13, v17, s71
    v_perm_b32 v128, v25, v29, s70
    v_perm_b32 v136, v25, v29, s71
    v_perm_b32 v129, v17, v21, s70
    v_perm_b32 v137, v17, v21, s71
    v_dot2_f32_bf16 v130, v126, v58, 0
    v_dot2_f32_bf16 v138, v134, v60, 0
    v_dot2_f32_bf16 v131, v128, v58, 0
    v_dot2_f32_bf16 v139, v136, v60, 0
    v_dot2_f32_bf16 v130, v127, v59, v130
    v_dot2_f32_bf16 v138, v135, v61, v138
    v_dot2_f32_bf16 v131, v129, v59, v131
    v_dot2_f32_bf16 v139, v137, v61, v139
    v_lshlrev_b32 v132, 16, v33
    v_and_b32 v140, s72, v33
    v_lshlrev_b32 v133, 16, v37
    v_and_b32 v141, s72, v37
    v_mul_f32 v130, v130, v132
    v_mul_f32 v138, v138, v140
    v_mul_f32 v131, v131, v133
    v_mul_f32 v139, v139, v141
    v_cvt_pk_bf16_f32 v130, v131, v130
    v_cvt_pk_bf16_f32 v138, v139, v138
    ds_write_b32 v95, v130 offset:768
    ds_write_b32 v95, v138 offset:896
    s_cmp_ge_u32 s3, 2
    s_cbranch_scc1 wc_9
    s_waitcnt vmcnt(0)
    s_branch wb_8
wc_9:
    s_cmp_eq_u32 s76, 0
    s_cbranch_scc1 wa_7
    s_waitcnt vmcnt(15)
    s_branch wb_8
wa_7:
    s_waitcnt vmcnt(8)
wb_8:
    ds_write2_b32 v96, v38, v42 offset0:0 offset1:1
    ds_write2_b32 v96, v39, v43 offset0:64 offset1:65
    ds_write2_b32 v96, v40, v44 offset0:128 offset1:129
    ds_write2_b32 v96, v41, v45 offset0:192 offset1:193
    s_waitcnt lgkmcnt(0)
    s_barrier
    s_cmp_ge_u32 s3, 2
    s_cbranch_scc1 dmaw_10
    v_mov_b32 v248, 0
    global_load_dword v249, v248, s[32:33] sc1
    ds_read_b128 v[10:13], v100
    v_xor_b32 v110, 32, v100
    ds_read_b128 v[14:17], v110 offset:2048
    v_xor_b32 v110, 64, v100
    ds_read_b128 v[18:21], v110 offset:4096
    v_xor_b32 v110, 96, v100
    ds_read_b128 v[22:25], v110 offset:6144
    ds_read_b128 v[26:29], v106
    v_xor_b32 v111, 32, v106
    ds_read_b128 v[30:33], v111 offset:2048
    v_xor_b32 v111, 64, v106
    ds_read_b128 v[34:37], v111 offset:4096
    v_xor_b32 v111, 96, v106
    ds_read_b128 v[38:41], v111 offset:6144
    s_waitcnt lgkmcnt(7)
    global_store_dwordx4 v102, v[10:13], s[52:53] sc1
    v_add_u32 v102, 65536, v102
    s_waitcnt lgkmcnt(6)
    global_store_dwordx4 v102, v[14:17], s[52:53] sc1
    v_add_u32 v102, 65536, v102
    s_waitcnt lgkmcnt(5)
    global_store_dwordx4 v102, v[18:21], s[52:53] sc1
    v_add_u32 v102, 65536, v102
    s_waitcnt lgkmcnt(4)
    global_store_dwordx4 v102, v[22:25], s[52:53] sc1
    ds_read_b64_tr_b16 v[42:43], v123 offset:0
    ds_read_b64_tr_b16 v[44:45], v123 offset:3584
    ds_read_b64_tr_b16 v[46:47], v123 offset:128
    ds_read_b64_tr_b16 v[48:49], v123 offset:3712
    ds_read_b64_tr_b16 v[50:51], v123 offset:256
    ds_read_b64_tr_b16 v[52:53], v123 offset:3840
    ds_read_b64_tr_b16 v[54:55], v123 offset:384
    ds_read_b64_tr_b16 v[56:57], v123 offset:3968
    s_waitcnt lgkmcnt(8)
    global_store_dwordx4 v108, v[26:29], s[54:55] sc1
    v_add_u32 v108, 65536, v108
    global_store_dwordx4 v108, v[30:33], s[54:55] sc1
    v_add_u32 v108, 65536, v108
    global_store_dwordx4 v108, v[34:37], s[54:55] sc1
    v_add_u32 v108, 65536, v108
    global_store_dwordx4 v108, v[38:41], s[54:55] sc1
    s_waitcnt lgkmcnt(0)
    global_store_dwordx4 v124, v[42:45], s[62:63] sc1
    v_add_u32 v124, 229376, v124
    global_store_dwordx4 v124, v[46:49], s[62:63] sc1
    v_add_u32 v124, 229376, v124
    global_store_dwordx4 v124, v[50:53], s[62:63] sc1
    v_add_u32 v124, 229376, v124
    s_cmp_eq_u32 s3, 1
    s_cbranch_scc1 w2s_13
    global_store_dwordx4 v124, v[54:57], s[62:63] sc1
    s_branch w2t_14
w2s_13:
    v_subrev_u32 v124, 229376, v124
    s_nop 0
    global_store_dwordx4 v124, v[50:53], s[62:63] sc1
w2t_14:
    s_barrier
    s_waitcnt vmcnt(8)
    v_mov_b32 v110, 1
    s_mov_b64 s[64:65], exec
    s_mov_b64 exec, 1
    ds_add_rtn_u32 v111, v101, v110 offset:0
    s_waitcnt lgkmcnt(0)
    v_readfirstlane_b32 s66, v111
    s_mov_b64 exec, s[64:65]
    s_cmp_eq_u32 s66, 1
    s_cbranch_scc0 nl_15
    v_cmp_ne_u32 vcc, 1, v249
    s_cbranch_vccz initok_16
    s_mov_b32 s68, 2000000
poll_17:
    global_load_dword v247, v248, s[32:33] sc1
    s_waitcnt vmcnt(0)
    v_cmp_ne_u32 vcc, 1, v247
    s_cbranch_vccz polld_18
    s_sub_u32 s68, s68, 1
    s_cmp_lg_u32 s68, 0
    s_cbranch_scc1 poll_17
polld_18:
    v_mov_b32 v249, 1
initok_16:
    s_mov_b32 s66, s42
    s_lshl_b32 s67, s66, 7
    v_mov_b32 v245, s67
    v_mov_b32 v246, 1
    s_mov_b64 s[64:65], exec
    s_mov_b64 exec, 1
    global_atomic_add v245, v246, s[34:35] sc1
    s_mov_b64 exec, s[64:65]
nl_15:
    s_waitcnt vmcnt(0)
    v_mov_b32 v110, 1
    s_mov_b64 s[64:65], exec
    s_mov_b64 exec, 1
    ds_add_rtn_u32 v111, v101, v110 offset:4
    s_waitcnt lgkmcnt(0)
    v_readfirstlane_b32 s66, v111
    s_mov_b64 exec, s[64:65]
    s_cmp_eq_u32 s66, 3
    s_cbranch_scc0 nl_19
    v_cmp_ne_u32 vcc, 1, v249
    s_cbranch_vccz initok_20
    s_mov_b32 s68, 2000000
poll_21:
    global_load_dword v247, v248, s[32:33] sc1
    s_waitcnt vmcnt(0)
    v_cmp_ne_u32 vcc, 1, v247
    s_cbranch_vccz polld_22
    s_sub_u32 s68, s68, 1
    s_cmp_lg_u32 s68, 0
    s_cbranch_scc1 poll_21
polld_22:
    v_mov_b32 v249, 1
initok_20:
    s_add_u32 s66, s36, 8
    s_lshl_b32 s67, s66, 7
    v_mov_b32 v245, s67
    v_mov_b32 v246, 1
    s_mov_b64 s[64:65], exec
    s_mov_b64 exec, 1
    global_atomic_add v245, v246, s[34:35] sc1
    s_mov_b64 exec, s[64:65]
nl_19:
    v_lshrrev_b32 v10, 5, v1
    v_mul_u32_u24 v10, 4608, v10
    v_and_b32 v11, 31, v1
    v_lshl_add_u32 v10, v11, 4, v10
    v_add_u32 v10, 151808, v10
    v_mov_b32 v12, 0
    v_mov_b32 v13, 0
    v_mov_b32 v14, 0
    v_mov_b32 v15, 0
    ds_write_b128 v10, v[12:15]
    s_branch w1addr_11
dmaw_10:
    s_mov_b32 s44, s22
    s_mov_b32 s45, s23
    s_mov_b32 s46, 1605632
    s_mov_b32 s47, 0x20000
    v_lshrrev_b32 v11, 4, v1
    v_lshlrev_b32 v12, 2, v11
    v_and_b32 v13, 15, v1
    v_xor_b32 v12, v12, v13
    v_lshlrev_b32 v12, 4, v12
    v_mul_u32_u24 v11, 3584, v11
    v_add_u32 v11, v11, v12
    s_lshl_b32 s66, s39, 8
    v_add_u32 v11, s66, v11
    v_mov_b32 v13, s79
    s_lshl_b32 s77, s77, 16
    v_mov_b32 v12, s77
    ds_write_b32 v13, v12
    v_mov_b32 v248, 0
    global_load_dword v249, v248, s[32:33] sc1
    s_barrier
    s_cmp_eq_u32 s76, 0
    s_cbranch_scc1 nost2_23
    s_waitcnt vmcnt(1)
    v_dot2_f32_bf16 v16, v64, s73, 0
    v_dot2_f32_bf16 v17, v64, v64, 0
    v_dot2_f32_bf16 v18, v65, s73, 0
    v_dot2_f32_bf16 v19, v65, v65, 0
    v_dot2_f32_bf16 v16, v66, s73, v16
    v_dot2_f32_bf16 v17, v66, v66, v17
    v_dot2_f32_bf16 v18, v67, s73, v18
    v_dot2_f32_bf16 v19, v67, v67, v19
    v_dot2_f32_bf16 v16, v68, s73, v16
    v_dot2_f32_bf16 v17, v68, v68, v17
    v_dot2_f32_bf16 v18, v69, s73, v18
    v_dot2_f32_bf16 v19, v69, v69, v19
    v_dot2_f32_bf16 v16, v70, s73, v16
    v_dot2_f32_bf16 v17, v70, v70, v17
    v_dot2_f32_bf16 v18, v71, s73, v18
    v_dot2_f32_bf16 v19, v71, v71, v19
    v_dot2_f32_bf16 v16, v72, s73, v16
    v_dot2_f32_bf16 v17, v72, v72, v17
    v_dot2_f32_bf16 v18, v73, s73, v18
    v_dot2_f32_bf16 v19, v73, v73, v19
    v_dot2_f32_bf16 v16, v74, s73, v16
    v_dot2_f32_bf16 v17, v74, v74, v17
    v_dot2_f32_bf16 v18, v75, s73, v18
    v_dot2_f32_bf16 v19, v75, v75, v19
    v_dot2_f32_bf16 v16, v76, s73, v16
    v_dot2_f32_bf16 v17, v76, v76, v17
    v_dot2_f32_bf16 v18, v77, s73, v18
    v_dot2_f32_bf16 v19, v77, v77, v19
    v_dot2_f32_bf16 v16, v78, s73, v16
    v_dot2_f32_bf16 v17, v78, v78, v17
    v_dot2_f32_bf16 v18, v79, s73, v18
    v_dot2_f32_bf16 v19, v79, v79, v19
    v_dot2_f32_bf16 v16, v80, s73, v16
    v_dot2_f32_bf16 v17, v80, v80, v17
    v_dot2_f32_bf16 v18, v81, s73, v18
    v_dot2_f32_bf16 v19, v81, v81, v19
    v_dot2_f32_bf16 v16, v82, s73, v16
    v_dot2_f32_bf16 v17, v82, v82, v17
    v_dot2_f32_bf16 v18, v83, s73, v18
    v_dot2_f32_bf16 v19, v83, v83, v19
    v_dot2_f32_bf16 v16, v84, s73, v16
    v_dot2_f32_bf16 v17, v84, v84, v17
    v_dot2_f32_bf16 v18, v85, s73, v18
    v_dot2_f32_bf16 v19, v85, v85, v19
    v_dot2_f32_bf16 v16, v86, s73, v16
    v_dot2_f32_bf16 v17, v86, v86, v17
    v_dot2_f32_bf16 v18, v87, s73, v18
    v_dot2_f32_bf16 v19, v87, v87, v19
    v_dot2_f32_bf16 v16, v88, s73, v16
    v_dot2_f32_bf16 v17, v88, v88, v17
    v_dot2_f32_bf16 v18, v89, s73, v18
    v_dot2_f32_bf16 v19, v89, v89, v19
    v_dot2_f32_bf16 v16, v90, s73, v16
    v_dot2_f32_bf16 v17, v90, v90, v17
    v_dot2_f32_bf16 v18, v91, s73, v18
    v_dot2_f32_bf16 v19, v91, v91, v19
    s_nop 2
    v_add_f32 v16, v16, v18
    v_add_f32 v17, v17, v19
    s_nop 1
    v_add_f32_dpp v16, v16, v16 quad_perm:[1,0,3,2] row_mask:0xf bank_mask:0xf
    v_add_f32_dpp v17, v17, v17 quad_perm:[1,0,3,2] row_mask:0xf bank_mask:0xf
    s_nop 1
    v_add_f32_dpp v16, v16, v16 quad_perm:[2,3,0,1] row_mask:0xf bank_mask:0xf
    v_add_f32_dpp v17, v17, v17 quad_perm:[2,3,0,1] row_mask:0xf bank_mask:0xf
    s_nop 1
    v_add_f32_dpp v16, v16, v16 row_half_mirror row_mask:0xf bank_mask:0xf
    v_add_f32_dpp v17, v17, v17 row_half_mirror row_mask:0xf bank_mask:0xf
    s_mov_b32 s66, 0x3b124925
    v_mul_f32 v16, s66, v16
    v_mul_f32 v17, s66, v17
    v_fma_f32 v17, -v16, v16, v17
    v_add_f32 v17, 0x3727c5ac, v17
    v_rsq_f32 v17, v17
    v_lshlrev_b32 v120, 2, v120
    v_cmp_eq_u32 vcc, 0, v122
    v_mul_f32 v18, -v16, v17
    v_add_u32 v121, 8192, v120
    s_and_saveexec_b64 s[64:65], vcc
    global_store_dword v120, v17, s[58:59] sc1
    global_store_dword v121, v18, s[58:59] sc1
    s_mov_b64 exec, s[64:65]
nost2_23:
    s_waitcnt vmcnt(0)
    v_mov_b32 v110, 1
    s_mov_b64 s[64:65], exec
    s_mov_b64 exec, 1
    ds_add_rtn_u32 v111, v101, v110 offset:4
    s_waitcnt lgkmcnt(0)
    v_readfirstlane_b32 s66, v111
    s_mov_b64 exec, s[64:65]
    s_cmp_eq_u32 s66, 3
    s_cbranch_scc0 nl_24
    v_cmp_ne_u32 vcc, 1, v249
    s_cbranch_vccz initok_25
    s_mov_b32 s68, 2000000
poll_26:
    global_load_dword v247, v248, s[32:33] sc1
    s_waitcnt vmcnt(0)
    v_cmp_ne_u32 vcc, 1, v247
    s_cbranch_vccz polld_27
    s_sub_u32 s68, s68, 1
    s_cmp_lg_u32 s68, 0
    s_cbranch_scc1 poll_26
polld_27:
    v_mov_b32 v249, 1
initok_25:
    s_add_u32 s66, s36, 8
    s_lshl_b32 s67, s66, 7
    v_mov_b32 v245, s67
    v_mov_b32 v246, 1
    s_mov_b64 s[64:65], exec
    s_mov_b64 exec, 1
    global_atomic_add v245, v246, s[34:35] sc1
    s_mov_b64 exec, s[64:65]
nl_24:
gate_28:
    ds_read_b64 v[12:13], v101
    s_waitcnt lgkmcnt(0)
    v_add_u32 v12, v12, v13
    s_nop 0
    v_readfirstlane_b32 s66, v12
    s_nop 0
    s_cmp_lt_u32 s66, 6
    s_cbranch_scc1 gate_28
    s_sub_u32 s66, s3, 2
    s_mul_i32 s66, s66, 56
    s_mul_i32 s67, s66, 14336
    s_lshl_b32 s66, s66, 10
    s_add_u32 m0, s66, 0
    s_mov_b32 s69, 14
w1l_29:
    s_nop 0
    buffer_load_dwordx4 v11, s[44:47], s67 offen lds
    s_add_u32 m0, m0, 1024
    s_add_u32 s67, s67, 14336
    s_nop 0
    buffer_load_dwordx4 v11, s[44:47], s67 offen lds
    s_add_u32 m0, m0, 1024
    s_add_u32 s67, s67, 14336
    s_nop 0
    buffer_load_dwordx4 v11, s[44:47], s67 offen lds
    s_add_u32 m0, m0, 1024
    s_add_u32 s67, s67, 14336
    s_nop 0
    buffer_load_dwordx4 v11, s[44:47], s67 offen lds
    s_add_u32 m0, m0, 1024
    s_add_u32 s67, s67, 14336
    s_sub_u32 s69, s69, 1
    s_cmp_lg_u32 s69, 0
    s_cbranch_scc1 w1l_29
w1addr_11:
    s_lshl_b32 s66, s2, 2
    s_load_dword s74, s[18:19], s66
    v_and_b32 v194, 15, v1
    v_lshrrev_b32 v195, 4, v1
    v_lshlrev_b32 v196, 4, v194
    v_lshl_add_u32 v196, v195, 2, v196
    s_lshl_b32 s66, s3, 9
    v_add_u32 v196, s66, v196
    v_lshlrev_b32 v197, 2, v196
    v_mov_b32 v198, v197
    s_lshl_b32 s66, s2, 13
    v_add_u32 v197, s66, v197
    s_lshr_b32 s66, s3, 1
    s_and_b32 s67, s3, 1
    s_mul_i32 s68, s66, 8320
    s_lshl_b32 s69, s67, 8
    s_sub_u32 s68, s68, s69
    s_add_u32 s68, s68, 131104
    v_add_u32 v199, 1, v194
    v_lshrrev_b32 v199, 1, v199
    v_lshl_add_u32 v199, v195, 2, v199
    v_lshlrev_b32 v199, 2, v199
    v_and_b32 v200, 1, v194
    v_cmp_eq_u32 vcc, 0, v200
    v_mov_b32 v201, 4160
    v_add_u32 v199, s68, v199
    v_cndmask_b32 v201, 0, v201, vcc
    v_add_u32 v199, v199, v201
    v_add_u32 v200, 1024, v199
    v_add_u32 v201, 2048, v199
    v_add_u32 v202, 3072, v199
    s_mul_i32 s68, s66, 4608
    s_sub_u32 s68, s68, s69
    s_add_u32 s68, s68, 148448
    v_lshlrev_b32 v203, 5, v194
    v_sub_u32 v203, s68, v203
    v_lshl_add_u32 v203, v195, 4, v203
    s_cmp_eq_u32 s67, 0
    s_cselect_b32 s68, 64, 0
    v_lshl_add_u32 v204, v195, 3, v194
    v_add_u32 v204, s68, v204
    s_mov_b32 s75, 0xffff
    v_cmp_le_u32 vcc, 15, v204
    v_mov_b32 v205, s75
    s_nop 0
    v_cndmask_b32 v206, 0, v205, vcc
    v_cmp_le_u32 vcc, 14, v204
    v_mov_b32 v205, s72
    s_nop 0
    v_cndmask_b32 v205, 0, v205, vcc
    v_or_b32 v206, v206, v205
    v_cmp_le_u32 vcc, 13, v204
    v_mov_b32 v205, s75
    s_nop 0
    v_cndmask_b32 v207, 0, v205, vcc
    v_cmp_le_u32 vcc, 12, v204
    v_mov_b32 v205, s72
    s_nop 0
    v_cndmask_b32 v205, 0, v205, vcc
    v_or_b32 v207, v207, v205
    v_cmp_le_u32 vcc, 11, v204
    v_mov_b32 v205, s75
    s_nop 0
    v_cndmask_b32 v208, 0, v205, vcc
    v_cmp_le_u32 vcc, 10, v204
    v_mov_b32 v205, s72
    s_nop 0
    v_cndmask_b32 v205, 0, v205, vcc
    v_or_b32 v208, v208, v205
    v_cmp_le_u32 vcc, 9, v204
    v_mov_b32 v205, s75
    s_nop 0
    v_cndmask_b32 v209, 0, v205, vcc
    v_cmp_le_u32 vcc, 8, v204
    v_mov_b32 v205, s72
    s_nop 0
    v_cndmask_b32 v205, 0, v205, vcc
    v_or_b32 v209, v209, v205
    v_lshlrev_b32 v211, 4, v1
    s_lshl_b32 s66, s3, 13
    v_add_u32 v212, s66, v211
    v_add_u32 v212, 114688, v212
    s_lshl_b32 s66, s3, 11
    v_add_u32 v213, s66, v211
    v_add_u32 v213, 114688, v213
    s_lshl_b32 s66, s3, 10
    s_sub_u32 s66, 151288, s66
    v_lshlrev_b32 v210, 5, v194
    v_lshl_add_u32 v210, v195, 3, v210
    v_sub_u32 v210, s66, v210
    v_and_b32 v214, 7, v1
    v_add_u32 v214, 8, v214
    v_lshlrev_b32 v214, 7, v214
    s_mul_i32 s66, s41, 229376
    s_mul_i32 s67, s3, 28672
    s_add_u32 s81, s66, s67
    s_and_b32 s67, s3, 1
    s_mul_i32 s67, s67, 114688
    s_add_u32 s95, s81, 114688
    s_sub_u32 s95, s95, s67
    s_add_u32 s81, s81, s67
    s_mov_b32 s84, s62
    s_mov_b32 s85, s63
    s_mov_b32 s86, 1605632
    s_mov_b32 s87, 0x20000
    v_mov_b32 v138, 0
    v_mov_b32 v139, 0
    v_mov_b32 v140, 0
    v_mov_b32 v141, 0
    v_mov_b32 v142, 0
    v_mov_b32 v143, 0
    v_mov_b32 v144, 0
    v_mov_b32 v145, 0
    v_mov_b32 v146, 0
    v_mov_b32 v147, 0
    v_mov_b32 v148, 0
    v_mov_b32 v149, 0
    v_mov_b32 v150, 0
    v_mov_b32 v151, 0
    v_mov_b32 v152, 0
    v_mov_b32 v153, 0
    v_mov_b32 v154, 0
    v_mov_b32 v155, 0
    v_mov_b32 v156, 0
    v_mov_b32 v157, 0
    v_mov_b32 v158, 0
    v_mov_b32 v159, 0
    v_mov_b32 v160, 0
    v_mov_b32 v161, 0
    v_mov_b32 v162, 0
    v_mov_b32 v163, 0
    v_mov_b32 v164, 0
    v_mov_b32 v165, 0
    v_mov_b32 v166, 0
    v_mov_b32 v167, 0
    v_mov_b32 v168, 0
    v_mov_b32 v169, 0
    s_cmp_lg_u32 s3, 0
    s_cbranch_scc1 w1n0_30
    v_cmp_ne_u32 vcc, 1, v249
    s_cbranch_vccz init0_31
    s_mov_b32 s68, 2000000
poll_32:
    global_load_dword v247, v248, s[32:33] sc1
    s_waitcnt vmcnt(0)
    v_cmp_ne_u32 vcc, 1, v247
    s_cbranch_vccz polld_33
    s_sub_u32 s68, s68, 1
    s_cmp_lg_u32 s68, 0
    s_cbranch_scc1 poll_32
polld_33:
init0_31:
    s_lshl_b32 s66, s42, 7
    v_mov_b32 v16, s66
    s_mov_b32 s68, 2000000
poll_34:
    global_load_dword v247, v16, s[34:35] sc1
    s_waitcnt vmcnt(0)
    v_cmp_ne_u32 vcc, 32, v247
    s_cbranch_vccz polld_35
    s_sub_u32 s68, s68, 1
    s_cmp_lg_u32 s68, 0
    s_cbranch_scc1 poll_34
polld_35:
    v_lshlrev_b32 v10, 4, v1
    s_lshl_b32 s66, s2, 13
    v_add_u32 v10, s66, v10
    s_mov_b32 m0, 147712
    s_nop 0
    global_load_lds_dwordx4 v10, s[52:53] sc1
    v_add_u32 v10, 1024, v10
    s_add_u32 m0, m0, 1024
    s_nop 0
    global_load_lds_dwordx4 v10, s[52:53] sc1
    v_add_u32 v10, 1024, v10
    s_add_u32 m0, m0, 1024
    s_nop 0
    global_load_lds_dwordx4 v10, s[52:53] sc1
    v_add_u32 v10, 1024, v10
    s_add_u32 m0, m0, 1024
    s_nop 0
    global_load_lds_dwordx4 v10, s[52:53] sc1
    v_add_u32 v10, 1024, v10
    s_add_u32 m0, m0, 1536
    s_nop 0
    global_load_lds_dwordx4 v10, s[52:53] sc1
    v_add_u32 v10, 1024, v10
    s_add_u32 m0, m0, 1024
    s_nop 0
    global_load_lds_dwordx4 v10, s[52:53] sc1
    v_add_u32 v10, 1024, v10
    s_add_u32 m0, m0, 1024
    s_nop 0
    global_load_lds_dwordx4 v10, s[52:53] sc1
    v_add_u32 v10, 1024, v10
    s_add_u32 m0, m0, 1024
    s_nop 0
    global_load_lds_dwordx4 v10, s[52:53] sc1
    v_add_u32 v10, 1024, v10
    s_add_u32 m0, m0, 1536
    s_waitcnt vmcnt(0) lgkmcnt(0)
    s_branch w1join_12
w1n0_30:
    s_waitcnt lgkmcnt(0)
    s_cmp_eq_u32 s3, 1
    s_cbranch_scc1 w1join_12
    s_waitcnt vmcnt(56) lgkmcnt(0)
w1join_12:
    s_barrier
    ds_read_b128 v[74:77], v203 offset:3776
    ds_read2_b32 v[10:11], v199 offset0:112 offset1:113
    ds_read2_b32 v[12:13], v199 offset0:114 offset1:115
    ds_read2_b32 v[14:15], v199 offset0:240 offset1:241
    ds_read2_b32 v[16:17], v199 offset0:242 offset1:243
    ds_read2_b32 v[18:19], v200 offset0:112 offset1:113
    ds_read2_b32 v[20:21], v200 offset0:114 offset1:115
    ds_read2_b32 v[22:23], v200 offset0:240 offset1:241
    ds_read2_b32 v[24:25], v200 offset0:242 offset1:243
    ds_read2_b32 v[26:27], v201 offset0:112 offset1:113
    ds_read2_b32 v[28:29], v201 offset0:114 offset1:115
    ds_read2_b32 v[30:31], v201 offset0:240 offset1:241
    ds_read2_b32 v[32:33], v201 offset0:242 offset1:243
    ds_read2_b32 v[34:35], v202 offset0:112 offset1:113
    ds_read2_b32 v[36:37], v202 offset0:114 offset1:115
    ds_read2_b32 v[38:39], v202 offset0:240 offset1:241
    ds_read2_b32 v[40:41], v202 offset0:242 offset1:243
    ds_read_b128 v[78:81], v203 offset:3264
    ds_read_b128 v[82:85], v203 offset:2752
    ds_read_b128 v[86:89], v203 offset:2240
    ds_read_b128 v[90:93], v203 offset:1728
    ds_read_b128 v[94:97], v203 offset:1216
    ds_read_b128 v[98:101], v203 offset:704
    ds_read_b128 v[102:105], v203 offset:192
    global_load_dword v215, v214, s[34:35] sc1
    s_waitcnt lgkmcnt(15)
    v_mfma_f32_16x16x32_bf16 v[138:141], v[10:13], v[74:77], v[138:141]
    s_waitcnt lgkmcnt(15)
    v_mfma_f32_16x16x32_bf16 v[142:145], v[14:17], v[74:77], v[142:145]
    s_waitcnt lgkmcnt(15)
    v_mfma_f32_16x16x32_bf16 v[146:149], v[18:21], v[74:77], v[146:149]
    s_waitcnt lgkmcnt(15)
    v_mfma_f32_16x16x32_bf16 v[150:153], v[22:25], v[74:77], v[150:153]
    s_waitcnt lgkmcnt(13)
    v_mfma_f32_16x16x32_bf16 v[154:157], v[26:29], v[74:77], v[154:157]
    s_waitcnt lgkmcnt(11)
    v_mfma_f32_16x16x32_bf16 v[158:161], v[30:33], v[74:77], v[158:161]
    s_waitcnt lgkmcnt(9)
    v_mfma_f32_16x16x32_bf16 v[162:165], v[34:37], v[74:77], v[162:165]
    s_waitcnt lgkmcnt(7)
    v_mfma_f32_16x16x32_bf16 v[166:169], v[38:41], v[74:77], v[166:169]
    s_waitcnt lgkmcnt(6)
    v_mfma_f32_16x16x32_bf16 v[142:145], v[10:13], v[78:81], v[142:145]
    v_mfma_f32_16x16x32_bf16 v[146:149], v[14:17], v[78:81], v[146:149]
    v_mfma_f32_16x16x32_bf16 v[150:153], v[18:21], v[78:81], v[150:153]
    v_mfma_f32_16x16x32_bf16 v[154:157], v[22:25], v[78:81], v[154:157]
    v_mfma_f32_16x16x32_bf16 v[158:161], v[26:29], v[78:81], v[158:161]
    v_mfma_f32_16x16x32_bf16 v[162:165], v[30:33], v[78:81], v[162:165]
    v_mfma_f32_16x16x32_bf16 v[166:169], v[34:37], v[78:81], v[166:169]
    s_waitcnt lgkmcnt(0)
    v_mfma_f32_16x16x32_bf16 v[146:149], v[10:13], v[82:85], v[146:149]
    ds_read_b128 v[106:109], v203 offset:3712
    v_mfma_f32_16x16x32_bf16 v[150:153], v[14:17], v[82:85], v[150:153]
    ds_read_b128 v[110:113], v203 offset:3200
    v_mfma_f32_16x16x32_bf16 v[154:157], v[18:21], v[82:85], v[154:157]
    ds_read_b128 v[114:117], v203 offset:2688
    v_mfma_f32_16x16x32_bf16 v[158:161], v[22:25], v[82:85], v[158:161]
    ds_read_b128 v[118:121], v203 offset:2176
    v_mfma_f32_16x16x32_bf16 v[162:165], v[26:29], v[82:85], v[162:165]
    ds_read_b128 v[122:125], v203 offset:1664
    v_mfma_f32_16x16x32_bf16 v[166:169], v[30:33], v[82:85], v[166:169]
    ds_read_b128 v[126:129], v203 offset:1152
    v_mfma_f32_16x16x32_bf16 v[150:153], v[10:13], v[86:89], v[150:153]
    ds_read_b128 v[130:133], v203 offset:640
    ds_read_b128 v[134:137], v203 offset:128
    v_mfma_f32_16x16x32_bf16 v[154:157], v[14:17], v[86:89], v[154:157]
    ds_read2_b32 v[42:43], v199 offset0:96 offset1:97
    v_mfma_f32_16x16x32_bf16 v[158:161], v[18:21], v[86:89], v[158:161]
    ds_read2_b32 v[44:45], v199 offset0:98 offset1:99
    v_mfma_f32_16x16x32_bf16 v[162:165], v[22:25], v[86:89], v[162:165]
    ds_read2_b32 v[46:47], v199 offset0:224 offset1:225
    v_mfma_f32_16x16x32_bf16 v[166:169], v[26:29], v[86:89], v[166:169]
    ds_read2_b32 v[48:49], v199 offset0:226 offset1:227
    v_mfma_f32_16x16x32_bf16 v[154:157], v[10:13], v[90:93], v[154:157]
    ds_read2_b32 v[50:51], v200 offset0:96 offset1:97
    v_mfma_f32_16x16x32_bf16 v[158:161], v[14:17], v[90:93], v[158:161]
    ds_read2_b32 v[52:53], v200 offset0:98 offset1:99
    v_mfma_f32_16x16x32_bf16 v[162:165], v[18:21], v[90:93], v[162:165]
    ds_read2_b32 v[54:55], v200 offset0:224 offset1:225
    ds_read2_b32 v[56:57], v200 offset0:226 offset1:227
    v_mfma_f32_16x16x32_bf16 v[166:169], v[22:25], v[90:93], v[166:169]
    ds_read2_b32 v[58:59], v201 offset0:96 offset1:97
    v_mfma_f32_16x16x32_bf16 v[158:161], v[10:13], v[94:97], v[158:161]
    ds_read2_b32 v[60:61], v201 offset0:98 offset1:99
    v_mfma_f32_16x16x32_bf16 v[162:165], v[14:17], v[94:97], v[162:165]
    ds_read2_b32 v[62:63], v201 offset0:224 offset1:225
    v_mfma_f32_16x16x32_bf16 v[166:169], v[18:21], v[94:97], v[166:169]
    ds_read2_b32 v[64:65], v201 offset0:226 offset1:227
    v_mfma_f32_16x16x32_bf16 v[162:165], v[10:13], v[98:101], v[162:165]
    ds_read2_b32 v[66:67], v202 offset0:96 offset1:97
    v_mfma_f32_16x16x32_bf16 v[166:169], v[14:17], v[98:101], v[166:169]
    ds_read2_b32 v[68:69], v202 offset0:98 offset1:99
    v_mfma_f32_16x16x32_bf16 v[166:169], v[10:13], v[102:105], v[166:169]
    ds_read2_b32 v[70:71], v202 offset0:224 offset1:225
    ds_read2_b32 v[72:73], v202 offset0:226 offset1:227
    s_waitcnt lgkmcnt(0)
    s_cmp_lg_u32 s3, 0
    s_cbranch_scc1 auxok_36
    s_waitcnt vmcnt(0)
    v_cmp_ne_u32 vcc, 28, v215
    s_cbranch_vccz auxok_36
    s_mov_b32 s68, 2000000
poll_38:
    global_load_dword v247, v214, s[34:35] sc1
    s_waitcnt vmcnt(0)
    v_cmp_ne_u32 vcc, 28, v247
    s_cbranch_vccz polld_39
    s_sub_u32 s68, s68, 1
    s_cmp_lg_u32 s68, 0
    s_cbranch_scc1 poll_38
polld_39:
auxok_36:
    s_barrier
    v_add_u32 v216, 8192, v198
    global_load_dwordx4 v[170:173], v197, s[54:55] sc1
    global_load_dwordx4 v[174:177], v197, s[54:55] offset:1024 sc1
    global_load_dwordx4 v[178:181], v198, s[58:59] sc1
    global_load_dwordx4 v[182:185], v216, s[58:59] sc1
    global_load_dwordx4 v[186:189], v198, s[58:59] offset:1024 sc1
    global_load_dwordx4 v[190:193], v216, s[58:59] offset:1024 sc1
    v_mfma_f32_16x16x32_bf16 v[138:141], v[42:45], v[106:109], v[138:141]
    ds_read_b128 v[74:77], v203 offset:3648
    v_mfma_f32_16x16x32_bf16 v[142:145], v[46:49], v[106:109], v[142:145]
    ds_read_b128 v[78:81], v203 offset:3136
    s_add_u32 s82, s81, 0
    buffer_load_dwordx4 a[0:3], v211, s[84:87], s82 offen offset:0 sc1
    v_mfma_f32_16x16x32_bf16 v[146:149], v[50:53], v[106:109], v[146:149]
    ds_read_b128 v[82:85], v203 offset:2624
    v_mfma_f32_16x16x32_bf16 v[150:153], v[54:57], v[106:109], v[150:153]
    ds_read_b128 v[86:89], v203 offset:2112
    v_mfma_f32_16x16x32_bf16 v[154:157], v[58:61], v[106:109], v[154:157]
    ds_read_b128 v[90:93], v203 offset:1600
    v_mfma_f32_16x16x32_bf16 v[158:161], v[62:65], v[106:109], v[158:161]
    ds_read_b128 v[94:97], v203 offset:1088
    v_mfma_f32_16x16x32_bf16 v[162:165], v[66:69], v[106:109], v[162:165]
    ds_read_b128 v[98:101], v203 offset:576
    buffer_load_dwordx4 a[4:7], v211, s[84:87], s82 offen offset:1024 sc1
    v_mfma_f32_16x16x32_bf16 v[166:169], v[70:73], v[106:109], v[166:169]
    ds_read_b128 v[102:105], v203 offset:64
    v_mfma_f32_16x16x32_bf16 v[142:145], v[42:45], v[110:113], v[142:145]
    ds_read2_b32 v[10:11], v199 offset0:80 offset1:81
    v_mfma_f32_16x16x32_bf16 v[146:149], v[46:49], v[110:113], v[146:149]
    ds_read2_b32 v[12:13], v199 offset0:82 offset1:83
    v_mfma_f32_16x16x32_bf16 v[150:153], v[50:53], v[110:113], v[150:153]
    ds_read2_b32 v[14:15], v199 offset0:208 offset1:209
    v_mfma_f32_16x16x32_bf16 v[154:157], v[54:57], v[110:113], v[154:157]
    ds_read2_b32 v[16:17], v199 offset0:210 offset1:211
    buffer_load_dwordx4 a[8:11], v211, s[84:87], s82 offen offset:2048 sc1
    v_mfma_f32_16x16x32_bf16 v[158:161], v[58:61], v[110:113], v[158:161]
    ds_read2_b32 v[18:19], v200 offset0:80 offset1:81
    v_mfma_f32_16x16x32_bf16 v[162:165], v[62:65], v[110:113], v[162:165]
    ds_read2_b32 v[20:21], v200 offset0:82 offset1:83
    v_mfma_f32_16x16x32_bf16 v[166:169], v[66:69], v[110:113], v[166:169]
    ds_read2_b32 v[22:23], v200 offset0:208 offset1:209
    v_mfma_f32_16x16x32_bf16 v[146:149], v[42:45], v[114:117], v[146:149]
    ds_read2_b32 v[24:25], v200 offset0:210 offset1:211
    v_mfma_f32_16x16x32_bf16 v[150:153], v[46:49], v[114:117], v[150:153]
    ds_read2_b32 v[26:27], v201 offset0:80 offset1:81
    buffer_load_dwordx4 a[12:15], v211, s[84:87], s82 offen offset:3072 sc1
    v_mfma_f32_16x16x32_bf16 v[154:157], v[50:53], v[114:117], v[154:157]
    ds_read2_b32 v[28:29], v201 offset0:82 offset1:83
    v_mfma_f32_16x16x32_bf16 v[158:161], v[54:57], v[114:117], v[158:161]
    ds_read2_b32 v[30:31], v201 offset0:208 offset1:209
    v_mfma_f32_16x16x32_bf16 v[162:165], v[58:61], v[114:117], v[162:165]
    ds_read2_b32 v[32:33], v201 offset0:210 offset1:211
    v_mfma_f32_16x16x32_bf16 v[166:169], v[62:65], v[114:117], v[166:169]
    ds_read2_b32 v[34:35], v202 offset0:80 offset1:81
    v_mfma_f32_16x16x32_bf16 v[150:153], v[42:45], v[118:121], v[150:153]
    ds_read2_b32 v[36:37], v202 offset0:82 offset1:83
    s_add_u32 s82, s81, 4096
    buffer_load_dwordx4 a[16:19], v211, s[84:87], s82 offen offset:0 sc1
    v_mfma_f32_16x16x32_bf16 v[154:157], v[46:49], v[118:121], v[154:157]
    ds_read2_b32 v[38:39], v202 offset0:208 offset1:209
    v_mfma_f32_16x16x32_bf16 v[158:161], v[50:53], v[118:121], v[158:161]
    ds_read2_b32 v[40:41], v202 offset0:210 offset1:211
    v_mfma_f32_16x16x32_bf16 v[162:165], v[54:57], v[118:121], v[162:165]
    v_mfma_f32_16x16x32_bf16 v[166:169], v[58:61], v[118:121], v[166:169]
    v_mfma_f32_16x16x32_bf16 v[154:157], v[42:45], v[122:125], v[154:157]
    buffer_load_dwordx4 a[20:23], v211, s[84:87], s82 offen offset:1024 sc1
    v_mfma_f32_16x16x32_bf16 v[158:161], v[46:49], v[122:125], v[158:161]
    v_mfma_f32_16x16x32_bf16 v[162:165], v[50:53], v[122:125], v[162:165]
    v_mfma_f32_16x16x32_bf16 v[166:169], v[54:57], v[122:125], v[166:169]
    v_mfma_f32_16x16x32_bf16 v[158:161], v[42:45], v[126:129], v[158:161]
    v_mfma_f32_16x16x32_bf16 v[162:165], v[46:49], v[126:129], v[162:165]
    buffer_load_dwordx4 a[24:27], v211, s[84:87], s82 offen offset:2048 sc1
    v_mfma_f32_16x16x32_bf16 v[166:169], v[50:53], v[126:129], v[166:169]
    v_mfma_f32_16x16x32_bf16 v[162:165], v[42:45], v[130:133], v[162:165]
    v_mfma_f32_16x16x32_bf16 v[166:169], v[46:49], v[130:133], v[166:169]
    v_mfma_f32_16x16x32_bf16 v[166:169], v[42:45], v[134:137], v[166:169]
    s_waitcnt lgkmcnt(0)
    v_mfma_f32_16x16x32_bf16 v[138:141], v[10:13], v[74:77], v[138:141]
    ds_read_b128 v[106:109], v203 offset:3584
    v_mfma_f32_16x16x32_bf16 v[142:145], v[14:17], v[74:77], v[142:145]
    ds_read_b128 v[110:113], v203 offset:3072
    buffer_load_dwordx4 a[28:31], v211, s[84:87], s82 offen offset:3072 sc1
    v_mfma_f32_16x16x32_bf16 v[146:149], v[18:21], v[74:77], v[146:149]
    ds_read_b128 v[114:117], v203 offset:2560
    v_mfma_f32_16x16x32_bf16 v[150:153], v[22:25], v[74:77], v[150:153]
    ds_read_b128 v[118:121], v203 offset:2048
    v_mfma_f32_16x16x32_bf16 v[154:157], v[26:29], v[74:77], v[154:157]
    ds_read_b128 v[122:125], v203 offset:1536
    v_mfma_f32_16x16x32_bf16 v[158:161], v[30:33], v[74:77], v[158:161]
    ds_read_b128 v[126:129], v203 offset:1024
    v_mfma_f32_16x16x32_bf16 v[162:165], v[34:37], v[74:77], v[162:165]
    ds_read_b128 v[130:133], v203 offset:512
    s_add_u32 s82, s81, 8192
    buffer_load_dwordx4 a[32:35], v211, s[84:87], s82 offen offset:0 sc1
    v_mfma_f32_16x16x32_bf16 v[166:169], v[38:41], v[74:77], v[166:169]
    ds_read_b128 v[134:137], v203 offset:0
    v_mfma_f32_16x16x32_bf16 v[142:145], v[10:13], v[78:81], v[142:145]
    ds_read2_b32 v[42:43], v199 offset0:64 offset1:65
    v_mfma_f32_16x16x32_bf16 v[146:149], v[14:17], v[78:81], v[146:149]
    ds_read2_b32 v[44:45], v199 offset0:66 offset1:67
    v_mfma_f32_16x16x32_bf16 v[150:153], v[18:21], v[78:81], v[150:153]
    ds_read2_b32 v[46:47], v199 offset0:192 offset1:193
    v_mfma_f32_16x16x32_bf16 v[154:157], v[22:25], v[78:81], v[154:157]
    ds_read2_b32 v[48:49], v199 offset0:194 offset1:195
    buffer_load_dwordx4 a[36:39], v211, s[84:87], s82 offen offset:1024 sc1
    v_mfma_f32_16x16x32_bf16 v[158:161], v[26:29], v[78:81], v[158:161]
    ds_read2_b32 v[50:51], v200 offset0:64 offset1:65
    v_mfma_f32_16x16x32_bf16 v[162:165], v[30:33], v[78:81], v[162:165]
    ds_read2_b32 v[52:53], v200 offset0:66 offset1:67
    v_mfma_f32_16x16x32_bf16 v[166:169], v[34:37], v[78:81], v[166:169]
    ds_read2_b32 v[54:55], v200 offset0:192 offset1:193
    v_mfma_f32_16x16x32_bf16 v[146:149], v[10:13], v[82:85], v[146:149]
    ds_read2_b32 v[56:57], v200 offset0:194 offset1:195
    v_mfma_f32_16x16x32_bf16 v[150:153], v[14:17], v[82:85], v[150:153]
    ds_read2_b32 v[58:59], v201 offset0:64 offset1:65
    buffer_load_dwordx4 a[40:43], v211, s[84:87], s82 offen offset:2048 sc1
    v_mfma_f32_16x16x32_bf16 v[154:157], v[18:21], v[82:85], v[154:157]
    ds_read2_b32 v[60:61], v201 offset0:66 offset1:67
    v_mfma_f32_16x16x32_bf16 v[158:161], v[22:25], v[82:85], v[158:161]
    ds_read2_b32 v[62:63], v201 offset0:192 offset1:193
    v_mfma_f32_16x16x32_bf16 v[162:165], v[26:29], v[82:85], v[162:165]
    ds_read2_b32 v[64:65], v201 offset0:194 offset1:195
    v_mfma_f32_16x16x32_bf16 v[166:169], v[30:33], v[82:85], v[166:169]
    ds_read2_b32 v[66:67], v202 offset0:64 offset1:65
    v_mfma_f32_16x16x32_bf16 v[150:153], v[10:13], v[86:89], v[150:153]
    ds_read2_b32 v[68:69], v202 offset0:66 offset1:67
    buffer_load_dwordx4 a[44:47], v211, s[84:87], s82 offen offset:3072 sc1
    v_mfma_f32_16x16x32_bf16 v[154:157], v[14:17], v[86:89], v[154:157]
    ds_read2_b32 v[70:71], v202 offset0:192 offset1:193
    v_mfma_f32_16x16x32_bf16 v[158:161], v[18:21], v[86:89], v[158:161]
    ds_read2_b32 v[72:73], v202 offset0:194 offset1:195
    v_mfma_f32_16x16x32_bf16 v[162:165], v[22:25], v[86:89], v[162:165]
    v_mfma_f32_16x16x32_bf16 v[166:169], v[26:29], v[86:89], v[166:169]
    v_mfma_f32_16x16x32_bf16 v[154:157], v[10:13], v[90:93], v[154:157]
    s_add_u32 s82, s81, 12288
    buffer_load_dwordx4 a[48:51], v211, s[84:87], s82 offen offset:0 sc1
    v_mfma_f32_16x16x32_bf16 v[158:161], v[14:17], v[90:93], v[158:161]
    v_mfma_f32_16x16x32_bf16 v[162:165], v[18:21], v[90:93], v[162:165]
    v_mfma_f32_16x16x32_bf16 v[166:169], v[22:25], v[90:93], v[166:169]
    v_mfma_f32_16x16x32_bf16 v[158:161], v[10:13], v[94:97], v[158:161]
    v_mfma_f32_16x16x32_bf16 v[162:165], v[14:17], v[94:97], v[162:165]
    buffer_load_dwordx4 a[52:55], v211, s[84:87], s82 offen offset:1024 sc1
    v_mfma_f32_16x16x32_bf16 v[166:169], v[18:21], v[94:97], v[166:169]
    v_mfma_f32_16x16x32_bf16 v[162:165], v[10:13], v[98:101], v[162:165]
    v_mfma_f32_16x16x32_bf16 v[166:169], v[14:17], v[98:101], v[166:169]
    v_mfma_f32_16x16x32_bf16 v[166:169], v[10:13], v[102:105], v[166:169]
    s_waitcnt lgkmcnt(0)
    v_and_b32 v42, v206, v42
    v_and_b32 v43, v207, v43
    v_and_b32 v44, v208, v44
    v_and_b32 v45, v209, v45
    s_nop 1
    v_mfma_f32_16x16x32_bf16 v[138:141], v[42:45], v[106:109], v[138:141]
    v_mfma_f32_16x16x32_bf16 v[142:145], v[46:49], v[106:109], v[142:145]
    buffer_load_dwordx4 a[56:59], v211, s[84:87], s82 offen offset:2048 sc1
    v_mfma_f32_16x16x32_bf16 v[146:149], v[50:53], v[106:109], v[146:149]
    v_mfma_f32_16x16x32_bf16 v[150:153], v[54:57], v[106:109], v[150:153]
    v_mfma_f32_16x16x32_bf16 v[154:157], v[58:61], v[106:109], v[154:157]
    v_mfma_f32_16x16x32_bf16 v[158:161], v[62:65], v[106:109], v[158:161]
    v_mfma_f32_16x16x32_bf16 v[162:165], v[66:69], v[106:109], v[162:165]
    buffer_load_dwordx4 a[60:63], v211, s[84:87], s82 offen offset:3072 sc1
    v_mfma_f32_16x16x32_bf16 v[166:169], v[70:73], v[106:109], v[166:169]
    v_mfma_f32_16x16x32_bf16 v[142:145], v[42:45], v[110:113], v[142:145]
    v_mfma_f32_16x16x32_bf16 v[146:149], v[46:49], v[110:113], v[146:149]
    v_mfma_f32_16x16x32_bf16 v[150:153], v[50:53], v[110:113], v[150:153]
    v_mfma_f32_16x16x32_bf16 v[154:157], v[54:57], v[110:113], v[154:157]
    s_add_u32 s82, s81, 16384
    buffer_load_dwordx4 a[64:67], v211, s[84:87], s82 offen offset:0 sc1
    v_mfma_f32_16x16x32_bf16 v[158:161], v[58:61], v[110:113], v[158:161]
    v_mfma_f32_16x16x32_bf16 v[162:165], v[62:65], v[110:113], v[162:165]
    v_mfma_f32_16x16x32_bf16 v[166:169], v[66:69], v[110:113], v[166:169]
    v_mfma_f32_16x16x32_bf16 v[146:149], v[42:45], v[114:117], v[146:149]
    v_mfma_f32_16x16x32_bf16 v[150:153], v[46:49], v[114:117], v[150:153]
    buffer_load_dwordx4 a[68:71], v211, s[84:87], s82 offen offset:1024 sc1
    v_mfma_f32_16x16x32_bf16 v[154:157], v[50:53], v[114:117], v[154:157]
    v_mfma_f32_16x16x32_bf16 v[158:161], v[54:57], v[114:117], v[158:161]
    v_mfma_f32_16x16x32_bf16 v[162:165], v[58:61], v[114:117], v[162:165]
    v_mfma_f32_16x16x32_bf16 v[166:169], v[62:65], v[114:117], v[166:169]
    v_mfma_f32_16x16x32_bf16 v[150:153], v[42:45], v[118:121], v[150:153]
    buffer_load_dwordx4 a[72:75], v211, s[84:87], s82 offen offset:2048 sc1
    v_mfma_f32_16x16x32_bf16 v[154:157], v[46:49], v[118:121], v[154:157]
    v_mfma_f32_16x16x32_bf16 v[158:161], v[50:53], v[118:121], v[158:161]
    v_mfma_f32_16x16x32_bf16 v[162:165], v[54:57], v[118:121], v[162:165]
    v_mfma_f32_16x16x32_bf16 v[166:169], v[58:61], v[118:121], v[166:169]
    v_mfma_f32_16x16x32_bf16 v[154:157], v[42:45], v[122:125], v[154:157]
    buffer_load_dwordx4 a[76:79], v211, s[84:87], s82 offen offset:3072 sc1
    v_mfma_f32_16x16x32_bf16 v[158:161], v[46:49], v[122:125], v[158:161]
    v_mfma_f32_16x16x32_bf16 v[162:165], v[50:53], v[122:125], v[162:165]
    v_mfma_f32_16x16x32_bf16 v[166:169], v[54:57], v[122:125], v[166:169]
    v_mfma_f32_16x16x32_bf16 v[158:161], v[42:45], v[126:129], v[158:161]
    v_mfma_f32_16x16x32_bf16 v[162:165], v[46:49], v[126:129], v[162:165]
    s_add_u32 s82, s81, 20480
    buffer_load_dwordx4 a[80:83], v211, s[84:87], s82 offen offset:0 sc1
    v_mfma_f32_16x16x32_bf16 v[166:169], v[50:53], v[126:129], v[166:169]
    v_mfma_f32_16x16x32_bf16 v[162:165], v[42:45], v[130:133], v[162:165]
    v_mfma_f32_16x16x32_bf16 v[166:169], v[46:49], v[130:133], v[166:169]
    v_mfma_f32_16x16x32_bf16 v[166:169], v[42:45], v[134:137], v[166:169]
    s_barrier
    ds_write_b128 v212, v[138:141] offset:0
    buffer_load_dwordx4 a[84:87], v211, s[84:87], s82 offen offset:1024 sc1
    ds_write_b128 v212, v[142:145] offset:1024
    buffer_load_dwordx4 a[88:91], v211, s[84:87], s82 offen offset:2048 sc1
    ds_write_b128 v212, v[146:149] offset:2048
    buffer_load_dwordx4 a[92:95], v211, s[84:87], s82 offen offset:3072 sc1
    ds_write_b128 v212, v[150:153] offset:3072
    s_add_u32 s82, s81, 24576
    buffer_load_dwordx4 a[96:99], v211, s[84:87], s82 offen offset:0 sc1
    ds_write_b128 v212, v[154:157] offset:4096
    buffer_load_dwordx4 a[100:103], v211, s[84:87], s82 offen offset:1024 sc1
    ds_write_b128 v212, v[158:161] offset:5120
    buffer_load_dwordx4 a[104:107], v211, s[84:87], s82 offen offset:2048 sc1
    ds_write_b128 v212, v[162:165] offset:6144
    buffer_load_dwordx4 a[108:111], v211, s[84:87], s82 offen offset:3072 sc1
    ds_write_b128 v212, v[166:169] offset:7168
    s_waitcnt lgkmcnt(0)
    s_barrier
    ds_read_b128 v[10:13], v213 offset:0
    ds_read_b128 v[14:17], v213 offset:8192
    ds_read_b128 v[18:21], v213 offset:16384
    ds_read_b128 v[22:25], v213 offset:24576
    ds_read_b128 v[26:29], v213 offset:1024
    ds_read_b128 v[30:33], v213 offset:9216
    ds_read_b128 v[34:37], v213 offset:17408
    ds_read_b128 v[38:41], v213 offset:25600
    ds_read_b64 v[42:43], v210 offset:512
    ds_read_b64 v[44:45], v210 offset:5120
    ds_read_b64 v[46:47], v210 offset:0
    ds_read_b64 v[48:49], v210 offset:4608
    s_and_b32 s75, s74, s72
    s_lshl_b32 s74, s74, 16
    s_waitcnt vmcnt(28)
    v_lshlrev_b32 v50, 16, v170
    v_lshlrev_b32 v51, 16, v171
    v_lshlrev_b32 v52, 16, v172
    v_lshlrev_b32 v53, 16, v173
    v_pk_fma_f32 v[54:55], v[50:51], v[178:179], v[182:183]
    v_pk_fma_f32 v[56:57], v[52:53], v[180:181], v[184:185]
    v_and_b32 v58, s72, v170
    v_and_b32 v59, s72, v171
    v_and_b32 v60, s72, v172
    v_and_b32 v61, s72, v173
    v_pk_fma_f32 v[62:63], v[58:59], v[178:179], v[182:183]
    v_pk_fma_f32 v[64:65], v[60:61], v[180:181], v[184:185]
    s_waitcnt lgkmcnt(8)
    s_waitcnt lgkmcnt(2)
    v_pk_add_f32 v[10:11], v[10:11], v[14:15]
    v_pk_add_f32 v[18:19], v[18:19], v[22:23]
    v_pk_add_f32 v[12:13], v[12:13], v[16:17]
    v_pk_add_f32 v[20:21], v[20:21], v[24:25]
    v_and_b32 v66, s72, v43
    v_lshlrev_b32 v67, 16, v43
    v_and_b32 v68, s72, v42
    v_lshlrev_b32 v69, 16, v42
    v_pk_fma_f32 v[10:11], v[66:67], s[74:75], v[10:11] op_sel:[0,0,0] op_sel_hi:[1,0,1]
    v_pk_fma_f32 v[12:13], v[68:69], s[74:75], v[12:13] op_sel:[0,0,0] op_sel_hi:[1,0,1]
    v_pk_fma_f32 v[10:11], v[54:55], v[10:11], v[50:51]
    v_pk_fma_f32 v[12:13], v[56:57], v[12:13], v[52:53]
    v_and_b32 v70, s72, v45
    v_lshlrev_b32 v71, 16, v45
    v_and_b32 v72, s72, v44
    v_lshlrev_b32 v73, 16, v44
    v_pk_fma_f32 v[18:19], v[70:71], s[74:75], v[18:19] op_sel:[0,1,0] op_sel_hi:[1,1,1]
    v_pk_fma_f32 v[20:21], v[72:73], s[74:75], v[20:21] op_sel:[0,1,0] op_sel_hi:[1,1,1]
    v_pk_fma_f32 v[18:19], v[62:63], v[18:19], v[58:59]
    v_pk_fma_f32 v[20:21], v[64:65], v[20:21], v[60:61]
    v_cvt_pk_bf16_f32 v74, v10, v18
    v_cvt_pk_bf16_f32 v75, v11, v19
    v_cvt_pk_bf16_f32 v76, v12, v20
    v_cvt_pk_bf16_f32 v77, v13, v21
    global_store_dwordx4 v197, v[74:77], s[56:57] offset:0 sc1
    v_lshlrev_b32 v50, 16, v174
    v_lshlrev_b32 v51, 16, v175
    v_lshlrev_b32 v52, 16, v176
    v_lshlrev_b32 v53, 16, v177
    v_pk_fma_f32 v[54:55], v[50:51], v[186:187], v[190:191]
    v_pk_fma_f32 v[56:57], v[52:53], v[188:189], v[192:193]
    v_and_b32 v58, s72, v174
    v_and_b32 v59, s72, v175
    v_and_b32 v60, s72, v176
    v_and_b32 v61, s72, v177
    v_pk_fma_f32 v[62:63], v[58:59], v[186:187], v[190:191]
    v_pk_fma_f32 v[64:65], v[60:61], v[188:189], v[192:193]
    s_waitcnt lgkmcnt(0)
    v_pk_add_f32 v[26:27], v[26:27], v[30:31]
    v_pk_add_f32 v[34:35], v[34:35], v[38:39]
    v_pk_add_f32 v[28:29], v[28:29], v[32:33]
    v_pk_add_f32 v[36:37], v[36:37], v[40:41]
    v_and_b32 v66, s72, v47
    v_lshlrev_b32 v67, 16, v47
    v_and_b32 v68, s72, v46
    v_lshlrev_b32 v69, 16, v46
    v_pk_fma_f32 v[26:27], v[66:67], s[74:75], v[26:27] op_sel:[0,0,0] op_sel_hi:[1,0,1]
    v_pk_fma_f32 v[28:29], v[68:69], s[74:75], v[28:29] op_sel:[0,0,0] op_sel_hi:[1,0,1]
    v_pk_fma_f32 v[26:27], v[54:55], v[26:27], v[50:51]
    v_pk_fma_f32 v[28:29], v[56:57], v[28:29], v[52:53]
    v_and_b32 v70, s72, v49
    v_lshlrev_b32 v71, 16, v49
    v_and_b32 v72, s72, v48
    v_lshlrev_b32 v73, 16, v48
    v_pk_fma_f32 v[34:35], v[70:71], s[74:75], v[34:35] op_sel:[0,1,0] op_sel_hi:[1,1,1]
    v_pk_fma_f32 v[36:37], v[72:73], s[74:75], v[36:37] op_sel:[0,1,0] op_sel_hi:[1,1,1]
    v_pk_fma_f32 v[34:35], v[62:63], v[34:35], v[58:59]
    v_pk_fma_f32 v[36:37], v[64:65], v[36:37], v[60:61]
    v_cvt_pk_bf16_f32 v78, v26, v34
    v_cvt_pk_bf16_f32 v79, v27, v35
    v_cvt_pk_bf16_f32 v80, v28, v36
    v_cvt_pk_bf16_f32 v81, v29, v37
    global_store_dwordx4 v197, v[78:81], s[56:57] offset:1024 sc1
    s_waitcnt vmcnt(0)
    s_barrier
    s_cmp_lg_u32 s3, 0
    s_cbranch_scc1 s2w0_40
    s_add_u32 s66, s36, 16
    s_lshl_b32 s67, s66, 7
    v_mov_b32 v245, s67
    v_mov_b32 v246, 1
    s_mov_b64 s[64:65], exec
    s_mov_b64 exec, 1
    global_atomic_add v245, v246, s[34:35] sc1
    s_mov_b64 exec, s[64:65]
s2w0_40:
    v_lshrrev_b32 v10, 5, v1
    v_bfe_u32 v11, v1, 2, 2
    v_lshl_add_u32 v10, v10, 3, v11
    v_lshlrev_b32 v10, 8, v10
    v_bfe_u32 v12, v1, 4, 1
    v_bfe_u32 v13, v1, 1, 1
    v_lshl_add_u32 v12, v12, 1, v13
    v_lshlrev_b32 v12, 4, v12
    v_add_u32 v10, v10, v12
    v_and_b32 v12, 1, v1
    v_lshl_add_u32 v10, v12, 3, v10
    v_lshlrev_b32 v11, 6, v11
    s_lshl_b32 s66, s3, 6
    v_xor_b32 v16, s66, v11
    v_add_u32 v16, v16, v10
    v_add_u32 v17, 65536, v16
    s_lshl_b32 s66, s39, 7
    s_lshl_b32 s67, s3, 5
    s_add_u32 s66, s66, s67
    v_and_b32 v18, 31, v1
    v_add_u32 v18, s66, v18
    v_lshlrev_b32 v18, 1, v18
    global_load_ushort v15, v18, s[24:25]
    v_xor_b32 v240, 0, v11
    v_add_u32 v240, v240, v10
    v_xor_b32 v241, 64, v11
    v_add_u32 v241, v241, v10
    v_xor_b32 v242, 128, v11
    v_add_u32 v242, v242, v10
    v_xor_b32 v243, 192, v11
    v_add_u32 v243, v243, v10
    ds_read_b64_tr_b16 v[64:65], v16 offset:0
    ds_read_b64_tr_b16 v[66:67], v16 offset:1024
    s_add_u32 s82, s95, 0
    buffer_load_dwordx4 a[112:115], v211, s[84:87], s82 offen offset:0 sc1
    ds_read_b64_tr_b16 v[68:69], v16 offset:4096
    ds_read_b64_tr_b16 v[70:71], v16 offset:5120
    buffer_load_dwordx4 a[116:119], v211, s[84:87], s82 offen offset:1024 sc1
    ds_read_b64_tr_b16 v[72:73], v16 offset:8192
    ds_read_b64_tr_b16 v[74:75], v16 offset:9216
    buffer_load_dwordx4 a[120:123], v211, s[84:87], s82 offen offset:2048 sc1
    ds_read_b64_tr_b16 v[76:77], v16 offset:12288
    ds_read_b64_tr_b16 v[78:79], v16 offset:13312
    buffer_load_dwordx4 a[124:127], v211, s[84:87], s82 offen offset:3072 sc1
    ds_read_b64_tr_b16 v[80:81], v16 offset:16384
    ds_read_b64_tr_b16 v[82:83], v16 offset:17408
    s_add_u32 s82, s95, 4096
    buffer_load_dwordx4 a[128:131], v211, s[84:87], s82 offen offset:0 sc1
    ds_read_b64_tr_b16 v[84:85], v16 offset:20480
    ds_read_b64_tr_b16 v[86:87], v16 offset:21504
    buffer_load_dwordx4 a[132:135], v211, s[84:87], s82 offen offset:1024 sc1
    ds_read_b64_tr_b16 v[88:89], v16 offset:24576
    ds_read_b64_tr_b16 v[90:91], v16 offset:25600
    s_waitcnt lgkmcnt(12)
    v_dot2_f32_bf16 v42, v64, s73, 0
    v_dot2_f32_bf16 v43, v65, s73, 0
    v_dot2_f32_bf16 v44, v66, s73, 0
    v_dot2_f32_bf16 v45, v67, s73, 0
    buffer_load_dwordx4 a[136:139], v211, s[84:87], s82 offen offset:2048 sc1
    ds_read_b64_tr_b16 v[92:93], v16 offset:28672
    ds_read_b64_tr_b16 v[94:95], v16 offset:29696
    s_waitcnt lgkmcnt(12)
    v_dot2_f32_bf16 v42, v68, s73, v42
    v_dot2_f32_bf16 v43, v69, s73, v43
    v_dot2_f32_bf16 v44, v70, s73, v44
    v_dot2_f32_bf16 v45, v71, s73, v45
    buffer_load_dwordx4 a[140:143], v211, s[84:87], s82 offen offset:3072 sc1
    ds_read_b64_tr_b16 v[96:97], v16 offset:32768
    ds_read_b64_tr_b16 v[98:99], v16 offset:33792
    s_waitcnt lgkmcnt(12)
    v_dot2_f32_bf16 v42, v72, s73, v42
    v_dot2_f32_bf16 v43, v73, s73, v43
    v_dot2_f32_bf16 v44, v74, s73, v44
    v_dot2_f32_bf16 v45, v75, s73, v45
    s_add_u32 s82, s95, 8192
    buffer_load_dwordx4 a[144:147], v211, s[84:87], s82 offen offset:0 sc1
    ds_read_b64_tr_b16 v[100:101], v16 offset:36864
    ds_read_b64_tr_b16 v[102:103], v16 offset:37888
    s_waitcnt lgkmcnt(12)
    v_dot2_f32_bf16 v42, v76, s73, v42
    v_dot2_f32_bf16 v43, v77, s73, v43
    v_dot2_f32_bf16 v44, v78, s73, v44
    v_dot2_f32_bf16 v45, v79, s73, v45
    buffer_load_dwordx4 a[148:151], v211, s[84:87], s82 offen offset:1024 sc1
    ds_read_b64_tr_b16 v[104:105], v16 offset:40960
    ds_read_b64_tr_b16 v[106:107], v16 offset:41984
    s_waitcnt lgkmcnt(12)
    v_dot2_f32_bf16 v42, v80, s73, v42
    v_dot2_f32_bf16 v43, v81, s73, v43
    v_dot2_f32_bf16 v44, v82, s73, v44
    v_dot2_f32_bf16 v45, v83, s73, v45
    buffer_load_dwordx4 a[152:155], v211, s[84:87], s82 offen offset:2048 sc1
    ds_read_b64_tr_b16 v[108:109], v16 offset:45056
    ds_read_b64_tr_b16 v[110:111], v16 offset:46080
    s_waitcnt lgkmcnt(12)
    v_dot2_f32_bf16 v42, v84, s73, v42
    v_dot2_f32_bf16 v43, v85, s73, v43
    v_dot2_f32_bf16 v44, v86, s73, v44
    v_dot2_f32_bf16 v45, v87, s73, v45
    buffer_load_dwordx4 a[156:159], v211, s[84:87], s82 offen offset:3072 sc1
    ds_read_b64_tr_b16 v[112:113], v16 offset:49152
    ds_read_b64_tr_b16 v[114:115], v16 offset:50176
    s_waitcnt lgkmcnt(12)
    v_dot2_f32_bf16 v42, v88, s73, v42
    v_dot2_f32_bf16 v43, v89, s73, v43
    v_dot2_f32_bf16 v44, v90, s73, v44
    v_dot2_f32_bf16 v45, v91, s73, v45
    s_add_u32 s82, s95, 12288
    buffer_load_dwordx4 a[160:163], v211, s[84:87], s82 offen offset:0 sc1
    ds_read_b64_tr_b16 v[116:117], v16 offset:53248
    ds_read_b64_tr_b16 v[118:119], v16 offset:54272
    s_waitcnt lgkmcnt(12)
    v_dot2_f32_bf16 v42, v92, s73, v42
    v_dot2_f32_bf16 v43, v93, s73, v43
    v_dot2_f32_bf16 v44, v94, s73, v44
    v_dot2_f32_bf16 v45, v95, s73, v45
    buffer_load_dwordx4 a[164:167], v211, s[84:87], s82 offen offset:1024 sc1
    ds_read_b64_tr_b16 v[120:121], v16 offset:57344
    ds_read_b64_tr_b16 v[122:123], v16 offset:58368
    s_waitcnt lgkmcnt(12)
    v_dot2_f32_bf16 v42, v96, s73, v42
    v_dot2_f32_bf16 v43, v97, s73, v43
    v_dot2_f32_bf16 v44, v98, s73, v44
    v_dot2_f32_bf16 v45, v99, s73, v45
    buffer_load_dwordx4 a[168:171], v211, s[84:87], s82 offen offset:2048 sc1
    ds_read_b64_tr_b16 v[124:125], v16 offset:61440
    ds_read_b64_tr_b16 v[126:127], v16 offset:62464
    s_waitcnt lgkmcnt(12)
    v_dot2_f32_bf16 v42, v100, s73, v42
    v_dot2_f32_bf16 v43, v101, s73, v43
    v_dot2_f32_bf16 v44, v102, s73, v44
    v_dot2_f32_bf16 v45, v103, s73, v45
    buffer_load_dwordx4 a[172:175], v211, s[84:87], s82 offen offset:3072 sc1
    ds_read_b64_tr_b16 v[128:129], v17 offset:0
    ds_read_b64_tr_b16 v[130:131], v17 offset:1024
    s_waitcnt lgkmcnt(12)
    v_dot2_f32_bf16 v42, v104, s73, v42
    v_dot2_f32_bf16 v43, v105, s73, v43
    v_dot2_f32_bf16 v44, v106, s73, v44
    v_dot2_f32_bf16 v45, v107, s73, v45
    s_add_u32 s82, s95, 16384
    buffer_load_dwordx4 a[176:179], v211, s[84:87], s82 offen offset:0 sc1
    ds_read_b64_tr_b16 v[132:133], v17 offset:4096
    ds_read_b64_tr_b16 v[134:135], v17 offset:5120
    s_waitcnt lgkmcnt(12)
    v_dot2_f32_bf16 v42, v108, s73, v42
    v_dot2_f32_bf16 v43, v109, s73, v43
    v_dot2_f32_bf16 v44, v110, s73, v44
    v_dot2_f32_bf16 v45, v111, s73, v45
    buffer_load_dwordx4 a[180:183], v211, s[84:87], s82 offen offset:1024 sc1
    ds_read_b64_tr_b16 v[136:137], v17 offset:8192
    ds_read_b64_tr_b16 v[138:139], v17 offset:9216
    s_waitcnt lgkmcnt(12)
    v_dot2_f32_bf16 v42, v112, s73, v42
    v_dot2_f32_bf16 v43, v113, s73, v43
    v_dot2_f32_bf16 v44, v114, s73, v44
    v_dot2_f32_bf16 v45, v115, s73, v45
    buffer_load_dwordx4 a[184:187], v211, s[84:87], s82 offen offset:2048 sc1
    ds_read_b64_tr_b16 v[140:141], v17 offset:12288
    ds_read_b64_tr_b16 v[142:143], v17 offset:13312
    s_waitcnt lgkmcnt(12)
    v_dot2_f32_bf16 v42, v116, s73, v42
    v_dot2_f32_bf16 v43, v117, s73, v43
    v_dot2_f32_bf16 v44, v118, s73, v44
    v_dot2_f32_bf16 v45, v119, s73, v45
    buffer_load_dwordx4 a[188:191], v211, s[84:87], s82 offen offset:3072 sc1
    ds_read_b64_tr_b16 v[144:145], v17 offset:16384
    ds_read_b64_tr_b16 v[146:147], v17 offset:17408
    s_waitcnt lgkmcnt(12)
    v_dot2_f32_bf16 v42, v120, s73, v42
    v_dot2_f32_bf16 v43, v121, s73, v43
    v_dot2_f32_bf16 v44, v122, s73, v44
    v_dot2_f32_bf16 v45, v123, s73, v45
    s_add_u32 s82, s95, 20480
    buffer_load_dwordx4 a[192:195], v211, s[84:87], s82 offen offset:0 sc1
    ds_read_b64_tr_b16 v[148:149], v17 offset:20480
    ds_read_b64_tr_b16 v[150:151], v17 offset:21504
    s_waitcnt lgkmcnt(12)
    v_dot2_f32_bf16 v42, v124, s73, v42
    v_dot2_f32_bf16 v43, v125, s73, v43
    v_dot2_f32_bf16 v44, v126, s73, v44
    v_dot2_f32_bf16 v45, v127, s73, v45
    buffer_load_dwordx4 a[196:199], v211, s[84:87], s82 offen offset:1024 sc1
    ds_read_b64_tr_b16 v[152:153], v17 offset:24576
    ds_read_b64_tr_b16 v[154:155], v17 offset:25600
    s_waitcnt lgkmcnt(12)
    v_dot2_f32_bf16 v42, v128, s73, v42
    v_dot2_f32_bf16 v43, v129, s73, v43
    v_dot2_f32_bf16 v44, v130, s73, v44
    v_dot2_f32_bf16 v45, v131, s73, v45
    buffer_load_dwordx4 a[200:203], v211, s[84:87], s82 offen offset:2048 sc1
    ds_read_b64_tr_b16 v[156:157], v17 offset:28672
    ds_read_b64_tr_b16 v[158:159], v17 offset:29696
    s_waitcnt lgkmcnt(12)
    v_dot2_f32_bf16 v42, v132, s73, v42
    v_dot2_f32_bf16 v43, v133, s73, v43
    v_dot2_f32_bf16 v44, v134, s73, v44
    v_dot2_f32_bf16 v45, v135, s73, v45
    buffer_load_dwordx4 a[204:207], v211, s[84:87], s82 offen offset:3072 sc1
    ds_read_b64_tr_b16 v[160:161], v17 offset:32768
    ds_read_b64_tr_b16 v[162:163], v17 offset:33792
    s_waitcnt lgkmcnt(12)
    v_dot2_f32_bf16 v42, v136, s73, v42
    v_dot2_f32_bf16 v43, v137, s73, v43
    v_dot2_f32_bf16 v44, v138, s73, v44
    v_dot2_f32_bf16 v45, v139, s73, v45
    s_add_u32 s82, s95, 24576
    buffer_load_dwordx4 a[208:211], v211, s[84:87], s82 offen offset:0 sc1
    ds_read_b64_tr_b16 v[164:165], v17 offset:36864
    ds_read_b64_tr_b16 v[166:167], v17 offset:37888
    s_waitcnt lgkmcnt(12)
    v_dot2_f32_bf16 v42, v140, s73, v42
    v_dot2_f32_bf16 v43, v141, s73, v43
    v_dot2_f32_bf16 v44, v142, s73, v44
    v_dot2_f32_bf16 v45, v143, s73, v45
    buffer_load_dwordx4 a[212:215], v211, s[84:87], s82 offen offset:1024 sc1
    ds_read_b64_tr_b16 v[168:169], v17 offset:40960
    ds_read_b64_tr_b16 v[170:171], v17 offset:41984
    s_waitcnt lgkmcnt(12)
    v_dot2_f32_bf16 v42, v144, s73, v42
    v_dot2_f32_bf16 v43, v145, s73, v43
    v_dot2_f32_bf16 v44, v146, s73, v44
    v_dot2_f32_bf16 v45, v147, s73, v45
    buffer_load_dwordx4 a[216:219], v211, s[84:87], s82 offen offset:2048 sc1
    ds_read_b64_tr_b16 v[172:173], v17 offset:45056
    ds_read_b64_tr_b16 v[174:175], v17 offset:46080
    s_waitcnt lgkmcnt(12)
    v_dot2_f32_bf16 v42, v148, s73, v42
    v_dot2_f32_bf16 v43, v149, s73, v43
    v_dot2_f32_bf16 v44, v150, s73, v44
    v_dot2_f32_bf16 v45, v151, s73, v45
    buffer_load_dwordx4 a[220:223], v211, s[84:87], s82 offen offset:3072 sc1
    s_waitcnt lgkmcnt(10)
    v_dot2_f32_bf16 v42, v152, s73, v42
    v_dot2_f32_bf16 v43, v153, s73, v43
    v_dot2_f32_bf16 v44, v154, s73, v44
    v_dot2_f32_bf16 v45, v155, s73, v45
    s_waitcnt lgkmcnt(8)
    v_dot2_f32_bf16 v42, v156, s73, v42
    v_dot2_f32_bf16 v43, v157, s73, v43
    v_dot2_f32_bf16 v44, v158, s73, v44
    v_dot2_f32_bf16 v45, v159, s73, v45
    s_waitcnt lgkmcnt(6)
    v_dot2_f32_bf16 v42, v160, s73, v42
    v_dot2_f32_bf16 v43, v161, s73, v43
    v_dot2_f32_bf16 v44, v162, s73, v44
    v_dot2_f32_bf16 v45, v163, s73, v45
    s_waitcnt lgkmcnt(4)
    v_dot2_f32_bf16 v42, v164, s73, v42
    v_dot2_f32_bf16 v43, v165, s73, v43
    v_dot2_f32_bf16 v44, v166, s73, v44
    v_dot2_f32_bf16 v45, v167, s73, v45
    s_waitcnt lgkmcnt(2)
    v_dot2_f32_bf16 v42, v168, s73, v42
    v_dot2_f32_bf16 v43, v169, s73, v43
    v_dot2_f32_bf16 v44, v170, s73, v44
    v_dot2_f32_bf16 v45, v171, s73, v45
    s_waitcnt lgkmcnt(0)
    v_dot2_f32_bf16 v42, v172, s73, v42
    v_dot2_f32_bf16 v43, v173, s73, v43
    v_dot2_f32_bf16 v44, v174, s73, v44
    v_dot2_f32_bf16 v45, v175, s73, v45
    s_nop 2
    v_add_f32 v42, v42, v43
    v_add_f32 v44, v44, v45
    s_nop 0
    v_add_f32 v42, v42, v44
    v_mov_b32 v43, v42
    s_nop 1
    v_permlane32_swap_b32 v42, v43
    s_nop 1
    v_add_f32 v42, v42, v43
    v_cvt_pk_bf16_f32 v43, -v42, -v42
    v_and_b32 v44, s72, v43
    v_add_f32 v44, v42, v44
    v_cvt_pk_bf16_f32 v44, -v44, -v44
    s_waitcnt vmcnt(28)
    v_perm_b32 v46, v44, v43, s70
    v_perm_b32 v47, v15, v43, s70
    v_mov_b32 v48, v15
    v_mov_b32 v49, 0
    v_cmp_gt_u32 vcc, 32, v1
    v_lshlrev_b32 v50, 4, v1
    s_lshl_b32 s66, s3, 10
    s_add_u32 s66, s66, 156928
    v_cndmask_b32 v46, 0, v46, vcc
    v_cndmask_b32 v47, 0, v47, vcc
    v_cndmask_b32 v48, 0, v48, vcc
    v_add_u32 v50, s66, v50
    ds_write_b128 v50, v[46:49]
    v_lshrrev_b32 v10, 5, v1
    v_lshlrev_b32 v2, 13, v10
    v_and_b32 v11, 31, v1
    v_lshl_add_u32 v2, v11, 4, v2
    s_lshl_b32 s66, s38, 9
    s_lshl_b32 s67, s3, 15
    s_add_u32 s66, s66, s67
    v_add_u32 v2, s66, v2
    v_add_u32 v3, 15360, v2
    v_lshlrev_b32 v4, 11, v10
    v_lshl_add_u32 v4, v11, 2, v4
    s_lshl_b32 s66, s3, 7
    s_add_u32 s66, s66, 114688
    v_add_u32 v4, s66, v4
    s_mov_b32 s48, s56
    s_mov_b32 s49, s57
    s_mov_b32 s50, 1835008
    s_mov_b32 s51, 0x20000
    v_mov_b32 v6, v240
    v_mov_b32 v7, v241
    v_mov_b32 v8, v242
    v_mov_b32 v10, v243
    v_add_u32 v11, 65536, v240
    v_add_u32 v12, 65536, v241
    v_add_u32 v13, 65536, v242
    v_add_u32 v14, 65536, v243
    v_lshlrev_b32 v5, 4, v1
    v_add_u32 v5, 156928, v5
    s_nop 0
    s_mov_b32 s77, s39
    s_lshl_b32 s78, s3, 11
    s_add_u32 s78, s78, 114688
    s_waitcnt lgkmcnt(0)
    s_cmp_lg_u32 s3, 0
    s_cbranch_scc1 s2p_41
    v_and_b32 v16, 7, v1
    v_add_u32 v16, 16, v16
    v_lshlrev_b32 v16, 7, v16
    v_mov_b32 v17, 28
    s_mov_b32 s68, 2000000
poll_42:
    global_load_dword v247, v16, s[34:35] sc1
    s_waitcnt vmcnt(0)
    v_cmp_ne_u32 vcc, v17, v247
    s_cbranch_vccz polld_43
    s_sub_u32 s68, s68, 1
    s_cmp_lg_u32 s68, 0
    s_cbranch_scc1 poll_42
polld_43:
s2p_41:
    s_barrier
    s_add_u32 m0, s78, 0
    s_mov_b32 s76, 0
    buffer_load_dwordx4 v2, s[48:51], s76 offen sc1 lds
    buffer_load_dwordx4 v3, s[48:51], s76 offen offset:1024 sc1 lds
    s_add_u32 m0, s78, 8192
    s_mov_b32 s76, 131072
    buffer_load_dwordx4 v2, s[48:51], s76 offen sc1 lds
    buffer_load_dwordx4 v3, s[48:51], s76 offen offset:1024 sc1 lds
    s_add_u32 m0, s78, 16384
    s_mov_b32 s76, 262144
    buffer_load_dwordx4 v2, s[48:51], s76 offen sc1 lds
    buffer_load_dwordx4 v3, s[48:51], s76 offen offset:1024 sc1 lds
    s_add_u32 m0, s78, 24576
    s_mov_b32 s76, 393216
    buffer_load_dwordx4 v2, s[48:51], s76 offen sc1 lds
    buffer_load_dwordx4 v3, s[48:51], s76 offen offset:1024 sc1 lds
    s_add_u32 m0, s78, 32768
    s_mov_b32 s76, 524288
    buffer_load_dwordx4 v2, s[48:51], s76 offen sc1 lds
    buffer_load_dwordx4 v3, s[48:51], s76 offen offset:1024 sc1 lds
    ds_read_b128 a[224:227], v5 offset:0
    ds_read_b128 a[228:231], v5 offset:1024
    ds_read_b128 a[232:235], v5 offset:2048
    ds_read_b128 a[236:239], v5 offset:3072
    s_lshl_b32 s66, s38, 2
    s_add_u32 s66, s66, s3
    s_mul_i32 s66, s66, 56
    s_lshl_b32 s67, s39, 2
    s_add_u32 s66, s66, s67
    s_lshl_b32 s66, s66, 11
    v_lshl_add_u32 v240, v1, 4, s66
    v_add_u32 v241, 4096, v240
    v_mov_b32 v236, -1
    v_mov_b32 v237, -1
    v_mov_b32 v238, -1
    v_mov_b32 v239, -1
    ds_read_b64_tr_b16 v[192:193], v6 offset:0
    ds_read_b64_tr_b16 v[194:195], v6 offset:1024
    ds_read_b64_tr_b16 v[196:197], v7 offset:0
    ds_read_b64_tr_b16 v[198:199], v7 offset:1024
    ds_read_b64_tr_b16 v[200:201], v8 offset:0
    ds_read_b64_tr_b16 v[202:203], v8 offset:1024
    ds_read_b64_tr_b16 v[204:205], v10 offset:0
    ds_read_b64_tr_b16 v[206:207], v10 offset:1024
    s_waitcnt vmcnt(8) lgkmcnt(0)
    s_barrier
    ds_read2st64_b32 v[16:17], v4 offset0:0 offset1:2
    ds_read2st64_b32 v[18:19], v4 offset0:4 offset1:6
    ds_read2st64_b32 v[20:21], v4 offset0:16 offset1:18
    ds_read2st64_b32 v[22:23], v4 offset0:20 offset1:22
    s_add_u32 m0, s78, 40960
    s_mov_b32 s76, 655360
    buffer_load_dwordx4 v2, s[48:51], s76 offen sc1 lds
    buffer_load_dwordx4 v3, s[48:51], s76 offen offset:1024 sc1 lds
    s_waitcnt vmcnt(8) lgkmcnt(0)
    v_mfma_f32_32x32x16_bf16 v[128:143], v[192:195], v[16:19], 0
    ds_read_b64_tr_b16 v[208:209], v6 offset:4096
    ds_read_b64_tr_b16 v[210:211], v6 offset:5120
    ds_read_b64_tr_b16 v[212:213], v7 offset:4096
    ds_read_b64_tr_b16 v[214:215], v7 offset:5120
    v_mfma_f32_32x32x16_bf16 v[144:159], v[196:199], v[16:19], 0
    ds_read_b64_tr_b16 v[216:217], v8 offset:4096
    ds_read_b64_tr_b16 v[218:219], v8 offset:5120
    ds_read_b64_tr_b16 v[220:221], v10 offset:4096
    ds_read_b64_tr_b16 v[222:223], v10 offset:5120
    s_barrier
    v_mfma_f32_32x32x16_bf16 v[160:175], v[200:203], v[16:19], 0
    ds_read2st64_b32 v[24:25], v4 offset0:32 offset1:34
    ds_read2st64_b32 v[26:27], v4 offset0:36 offset1:38
    v_mfma_f32_32x32x16_bf16 v[176:191], v[204:207], v[16:19], 0
    ds_read2st64_b32 v[28:29], v4 offset0:48 offset1:50
    ds_read2st64_b32 v[30:31], v4 offset0:52 offset1:54
    s_waitcnt lgkmcnt(4)
    v_mfma_f32_32x32x16_bf16 v[128:143], v[208:211], v[20:23], v[128:143]
    ds_read_b64_tr_b16 v[192:193], v6 offset:8192
    ds_read_b64_tr_b16 v[194:195], v6 offset:9216
    ds_read_b64_tr_b16 v[196:197], v7 offset:8192
    ds_read_b64_tr_b16 v[198:199], v7 offset:9216
    v_mfma_f32_32x32x16_bf16 v[144:159], v[212:215], v[20:23], v[144:159]
    ds_read_b64_tr_b16 v[200:201], v8 offset:8192
    ds_read_b64_tr_b16 v[202:203], v8 offset:9216
    ds_read_b64_tr_b16 v[204:205], v10 offset:8192
    ds_read_b64_tr_b16 v[206:207], v10 offset:9216
    v_mfma_f32_32x32x16_bf16 v[160:175], v[216:219], v[20:23], v[160:175]
    s_add_u32 m0, s78, 0
    s_mov_b32 s76, 786432
    buffer_load_dwordx4 v2, s[48:51], s76 offen sc1 lds
    v_mfma_f32_32x32x16_bf16 v[176:191], v[220:223], v[20:23], v[176:191]
    buffer_load_dwordx4 v3, s[48:51], s76 offen offset:1024 sc1 lds
    s_waitcnt vmcnt(8) lgkmcnt(0)
    v_mfma_f32_32x32x16_bf16 v[128:143], v[192:195], v[24:27], v[128:143]
    ds_read_b64_tr_b16 v[208:209], v6 offset:12288
    ds_read_b64_tr_b16 v[210:211], v6 offset:13312
    ds_read_b64_tr_b16 v[212:213], v7 offset:12288
    ds_read_b64_tr_b16 v[214:215], v7 offset:13312
    v_mfma_f32_32x32x16_bf16 v[144:159], v[196:199], v[24:27], v[144:159]
    ds_read_b64_tr_b16 v[216:217], v8 offset:12288
    ds_read_b64_tr_b16 v[218:219], v8 offset:13312
    ds_read_b64_tr_b16 v[220:221], v10 offset:12288
    ds_read_b64_tr_b16 v[222:223], v10 offset:13312
    s_barrier
    v_mfma_f32_32x32x16_bf16 v[160:175], v[200:203], v[24:27], v[160:175]
    ds_read2st64_b32 v[32:33], v4 offset0:64 offset1:66
    ds_read2st64_b32 v[34:35], v4 offset0:68 offset1:70
    v_mfma_f32_32x32x16_bf16 v[176:191], v[204:207], v[24:27], v[176:191]
    ds_read2st64_b32 v[36:37], v4 offset0:80 offset1:82
    ds_read2st64_b32 v[38:39], v4 offset0:84 offset1:86
    s_waitcnt lgkmcnt(4)
    v_mfma_f32_32x32x16_bf16 v[128:143], v[208:211], v[28:31], v[128:143]
    ds_read_b64_tr_b16 v[192:193], v6 offset:16384
    ds_read_b64_tr_b16 v[194:195], v6 offset:17408
    ds_read_b64_tr_b16 v[196:197], v7 offset:16384
    ds_read_b64_tr_b16 v[198:199], v7 offset:17408
    v_mfma_f32_32x32x16_bf16 v[144:159], v[212:215], v[28:31], v[144:159]
    ds_read_b64_tr_b16 v[200:201], v8 offset:16384
    ds_read_b64_tr_b16 v[202:203], v8 offset:17408
    ds_read_b64_tr_b16 v[204:205], v10 offset:16384
    ds_read_b64_tr_b16 v[206:207], v10 offset:17408
    v_mfma_f32_32x32x16_bf16 v[160:175], v[216:219], v[28:31], v[160:175]
    s_add_u32 m0, s78, 8192
    s_mov_b32 s76, 917504
    buffer_load_dwordx4 v2, s[48:51], s76 offen sc1 lds
    v_mfma_f32_32x32x16_bf16 v[176:191], v[220:223], v[28:31], v[176:191]
    buffer_load_dwordx4 v3, s[48:51], s76 offen offset:1024 sc1 lds
    s_waitcnt vmcnt(8) lgkmcnt(0)
    v_mfma_f32_32x32x16_bf16 v[128:143], v[192:195], v[32:35], v[128:143]
    ds_read_b64_tr_b16 v[208:209], v6 offset:20480
    ds_read_b64_tr_b16 v[210:211], v6 offset:21504
    ds_read_b64_tr_b16 v[212:213], v7 offset:20480
    ds_read_b64_tr_b16 v[214:215], v7 offset:21504
    v_mfma_f32_32x32x16_bf16 v[144:159], v[196:199], v[32:35], v[144:159]
    ds_read_b64_tr_b16 v[216:217], v8 offset:20480
    ds_read_b64_tr_b16 v[218:219], v8 offset:21504
    ds_read_b64_tr_b16 v[220:221], v10 offset:20480
    ds_read_b64_tr_b16 v[222:223], v10 offset:21504
    s_barrier
    v_mfma_f32_32x32x16_bf16 v[160:175], v[200:203], v[32:35], v[160:175]
    ds_read2st64_b32 v[40:41], v4 offset0:96 offset1:98
    ds_read2st64_b32 v[42:43], v4 offset0:100 offset1:102
    v_mfma_f32_32x32x16_bf16 v[176:191], v[204:207], v[32:35], v[176:191]
    ds_read2st64_b32 v[44:45], v4 offset0:112 offset1:114
    ds_read2st64_b32 v[46:47], v4 offset0:116 offset1:118
    s_waitcnt lgkmcnt(4)
    v_mfma_f32_32x32x16_bf16 v[128:143], v[208:211], v[36:39], v[128:143]
    ds_read_b64_tr_b16 v[192:193], v6 offset:24576
    ds_read_b64_tr_b16 v[194:195], v6 offset:25600
    ds_read_b64_tr_b16 v[196:197], v7 offset:24576
    ds_read_b64_tr_b16 v[198:199], v7 offset:25600
    v_mfma_f32_32x32x16_bf16 v[144:159], v[212:215], v[36:39], v[144:159]
    ds_read_b64_tr_b16 v[200:201], v8 offset:24576
    ds_read_b64_tr_b16 v[202:203], v8 offset:25600
    ds_read_b64_tr_b16 v[204:205], v10 offset:24576
    ds_read_b64_tr_b16 v[206:207], v10 offset:25600
    v_mfma_f32_32x32x16_bf16 v[160:175], v[216:219], v[36:39], v[160:175]
    s_add_u32 m0, s78, 16384
    s_mov_b32 s76, 1048576
    buffer_load_dwordx4 v2, s[48:51], s76 offen sc1 lds
    v_mfma_f32_32x32x16_bf16 v[176:191], v[220:223], v[36:39], v[176:191]
    buffer_load_dwordx4 v3, s[48:51], s76 offen offset:1024 sc1 lds
    s_waitcnt vmcnt(8) lgkmcnt(0)
    v_mfma_f32_32x32x16_bf16 v[128:143], v[192:195], v[40:43], v[128:143]
    ds_read_b64_tr_b16 v[208:209], v6 offset:28672
    ds_read_b64_tr_b16 v[210:211], v6 offset:29696
    ds_read_b64_tr_b16 v[212:213], v7 offset:28672
    ds_read_b64_tr_b16 v[214:215], v7 offset:29696
    v_mfma_f32_32x32x16_bf16 v[144:159], v[196:199], v[40:43], v[144:159]
    ds_read_b64_tr_b16 v[216:217], v8 offset:28672
    ds_read_b64_tr_b16 v[218:219], v8 offset:29696
    ds_read_b64_tr_b16 v[220:221], v10 offset:28672
    ds_read_b64_tr_b16 v[222:223], v10 offset:29696
    s_barrier
    v_mfma_f32_32x32x16_bf16 v[160:175], v[200:203], v[40:43], v[160:175]
    ds_read2st64_b32 v[48:49], v4 offset0:128 offset1:130
    ds_read2st64_b32 v[50:51], v4 offset0:132 offset1:134
    v_mfma_f32_32x32x16_bf16 v[176:191], v[204:207], v[40:43], v[176:191]
    ds_read2st64_b32 v[52:53], v4 offset0:144 offset1:146
    ds_read2st64_b32 v[54:55], v4 offset0:148 offset1:150
    s_waitcnt lgkmcnt(4)
    v_mfma_f32_32x32x16_bf16 v[128:143], v[208:211], v[44:47], v[128:143]
    ds_read_b64_tr_b16 v[192:193], v6 offset:32768
    ds_read_b64_tr_b16 v[194:195], v6 offset:33792
    ds_read_b64_tr_b16 v[196:197], v7 offset:32768
    ds_read_b64_tr_b16 v[198:199], v7 offset:33792
    v_mfma_f32_32x32x16_bf16 v[144:159], v[212:215], v[44:47], v[144:159]
    ds_read_b64_tr_b16 v[200:201], v8 offset:32768
    ds_read_b64_tr_b16 v[202:203], v8 offset:33792
    ds_read_b64_tr_b16 v[204:205], v10 offset:32768
    ds_read_b64_tr_b16 v[206:207], v10 offset:33792
    v_mfma_f32_32x32x16_bf16 v[160:175], v[216:219], v[44:47], v[160:175]
    s_add_u32 m0, s78, 24576
    s_mov_b32 s76, 1179648
    buffer_load_dwordx4 v2, s[48:51], s76 offen sc1 lds
    v_mfma_f32_32x32x16_bf16 v[176:191], v[220:223], v[44:47], v[176:191]
    buffer_load_dwordx4 v3, s[48:51], s76 offen offset:1024 sc1 lds
    s_waitcnt vmcnt(8) lgkmcnt(0)
    v_mfma_f32_32x32x16_bf16 v[128:143], v[192:195], v[48:51], v[128:143]
    ds_read_b64_tr_b16 v[208:209], v6 offset:36864
    ds_read_b64_tr_b16 v[210:211], v6 offset:37888
    ds_read_b64_tr_b16 v[212:213], v7 offset:36864
    ds_read_b64_tr_b16 v[214:215], v7 offset:37888
    v_mfma_f32_32x32x16_bf16 v[144:159], v[196:199], v[48:51], v[144:159]
    ds_read_b64_tr_b16 v[216:217], v8 offset:36864
    ds_read_b64_tr_b16 v[218:219], v8 offset:37888
    ds_read_b64_tr_b16 v[220:221], v10 offset:36864
    ds_read_b64_tr_b16 v[222:223], v10 offset:37888
    s_barrier
    v_mfma_f32_32x32x16_bf16 v[160:175], v[200:203], v[48:51], v[160:175]
    ds_read2st64_b32 v[56:57], v4 offset0:160 offset1:162
    ds_read2st64_b32 v[58:59], v4 offset0:164 offset1:166
    v_mfma_f32_32x32x16_bf16 v[176:191], v[204:207], v[48:51], v[176:191]
    ds_read2st64_b32 v[60:61], v4 offset0:176 offset1:178
    ds_read2st64_b32 v[62:63], v4 offset0:180 offset1:182
    s_waitcnt lgkmcnt(4)
    v_mfma_f32_32x32x16_bf16 v[128:143], v[208:211], v[52:55], v[128:143]
    ds_read_b64_tr_b16 v[192:193], v6 offset:40960
    ds_read_b64_tr_b16 v[194:195], v6 offset:41984
    ds_read_b64_tr_b16 v[196:197], v7 offset:40960
    ds_read_b64_tr_b16 v[198:199], v7 offset:41984
    v_mfma_f32_32x32x16_bf16 v[144:159], v[212:215], v[52:55], v[144:159]
    ds_read_b64_tr_b16 v[200:201], v8 offset:40960
    ds_read_b64_tr_b16 v[202:203], v8 offset:41984
    ds_read_b64_tr_b16 v[204:205], v10 offset:40960
    ds_read_b64_tr_b16 v[206:207], v10 offset:41984
    v_mfma_f32_32x32x16_bf16 v[160:175], v[216:219], v[52:55], v[160:175]
    s_add_u32 m0, s78, 32768
    s_mov_b32 s76, 1310720
    buffer_load_dwordx4 v2, s[48:51], s76 offen sc1 lds
    v_mfma_f32_32x32x16_bf16 v[176:191], v[220:223], v[52:55], v[176:191]
    buffer_load_dwordx4 v3, s[48:51], s76 offen offset:1024 sc1 lds
    s_waitcnt vmcnt(8) lgkmcnt(0)
    v_mfma_f32_32x32x16_bf16 v[128:143], v[192:195], v[56:59], v[128:143]
    ds_read_b64_tr_b16 v[208:209], v6 offset:45056
    ds_read_b64_tr_b16 v[210:211], v6 offset:46080
    ds_read_b64_tr_b16 v[212:213], v7 offset:45056
    ds_read_b64_tr_b16 v[214:215], v7 offset:46080
    v_mfma_f32_32x32x16_bf16 v[144:159], v[196:199], v[56:59], v[144:159]
    ds_read_b64_tr_b16 v[216:217], v8 offset:45056
    ds_read_b64_tr_b16 v[218:219], v8 offset:46080
    ds_read_b64_tr_b16 v[220:221], v10 offset:45056
    ds_read_b64_tr_b16 v[222:223], v10 offset:46080
    s_barrier
    v_mfma_f32_32x32x16_bf16 v[160:175], v[200:203], v[56:59], v[160:175]
    ds_read2st64_b32 v[64:65], v4 offset0:0 offset1:2
    ds_read2st64_b32 v[66:67], v4 offset0:4 offset1:6
    v_mfma_f32_32x32x16_bf16 v[176:191], v[204:207], v[56:59], v[176:191]
    ds_read2st64_b32 v[68:69], v4 offset0:16 offset1:18
    ds_read2st64_b32 v[70:71], v4 offset0:20 offset1:22
    s_waitcnt lgkmcnt(4)
    v_mfma_f32_32x32x16_bf16 v[128:143], v[208:211], v[60:63], v[128:143]
    ds_read_b64_tr_b16 v[192:193], v6 offset:49152
    ds_read_b64_tr_b16 v[194:195], v6 offset:50176
    ds_read_b64_tr_b16 v[196:197], v7 offset:49152
    ds_read_b64_tr_b16 v[198:199], v7 offset:50176
    v_mfma_f32_32x32x16_bf16 v[144:159], v[212:215], v[60:63], v[144:159]
    ds_read_b64_tr_b16 v[200:201], v8 offset:49152
    ds_read_b64_tr_b16 v[202:203], v8 offset:50176
    ds_read_b64_tr_b16 v[204:205], v10 offset:49152
    ds_read_b64_tr_b16 v[206:207], v10 offset:50176
    v_mfma_f32_32x32x16_bf16 v[160:175], v[216:219], v[60:63], v[160:175]
    s_add_u32 m0, s78, 40960
    s_mov_b32 s76, 1441792
    buffer_load_dwordx4 v2, s[48:51], s76 offen sc1 lds
    v_mfma_f32_32x32x16_bf16 v[176:191], v[220:223], v[60:63], v[176:191]
    buffer_load_dwordx4 v3, s[48:51], s76 offen offset:1024 sc1 lds
    s_waitcnt vmcnt(8) lgkmcnt(0)
    v_mfma_f32_32x32x16_bf16 v[128:143], v[192:195], v[64:67], v[128:143]
    ds_read_b64_tr_b16 v[208:209], v6 offset:53248
    ds_read_b64_tr_b16 v[210:211], v6 offset:54272
    ds_read_b64_tr_b16 v[212:213], v7 offset:53248
    ds_read_b64_tr_b16 v[214:215], v7 offset:54272
    v_mfma_f32_32x32x16_bf16 v[144:159], v[196:199], v[64:67], v[144:159]
    ds_read_b64_tr_b16 v[216:217], v8 offset:53248
    ds_read_b64_tr_b16 v[218:219], v8 offset:54272
    ds_read_b64_tr_b16 v[220:221], v10 offset:53248
    ds_read_b64_tr_b16 v[222:223], v10 offset:54272
    s_barrier
    v_mfma_f32_32x32x16_bf16 v[160:175], v[200:203], v[64:67], v[160:175]
    ds_read2st64_b32 v[72:73], v4 offset0:32 offset1:34
    ds_read2st64_b32 v[74:75], v4 offset0:36 offset1:38
    v_mfma_f32_32x32x16_bf16 v[176:191], v[204:207], v[64:67], v[176:191]
    ds_read2st64_b32 v[76:77], v4 offset0:48 offset1:50
    ds_read2st64_b32 v[78:79], v4 offset0:52 offset1:54
    s_waitcnt lgkmcnt(4)
    v_mfma_f32_32x32x16_bf16 v[128:143], v[208:211], v[68:71], v[128:143]
    ds_read_b64_tr_b16 v[192:193], v6 offset:57344
    ds_read_b64_tr_b16 v[194:195], v6 offset:58368
    ds_read_b64_tr_b16 v[196:197], v7 offset:57344
    ds_read_b64_tr_b16 v[198:199], v7 offset:58368
    v_mfma_f32_32x32x16_bf16 v[144:159], v[212:215], v[68:71], v[144:159]
    ds_read_b64_tr_b16 v[200:201], v8 offset:57344
    ds_read_b64_tr_b16 v[202:203], v8 offset:58368
    ds_read_b64_tr_b16 v[204:205], v10 offset:57344
    ds_read_b64_tr_b16 v[206:207], v10 offset:58368
    v_mfma_f32_32x32x16_bf16 v[160:175], v[216:219], v[68:71], v[160:175]
    s_add_u32 m0, s78, 0
    s_mov_b32 s76, 1572864
    buffer_load_dwordx4 v2, s[48:51], s76 offen sc1 lds
    v_mfma_f32_32x32x16_bf16 v[176:191], v[220:223], v[68:71], v[176:191]
    buffer_load_dwordx4 v3, s[48:51], s76 offen offset:1024 sc1 lds
    s_waitcnt vmcnt(8) lgkmcnt(0)
    v_mfma_f32_32x32x16_bf16 v[128:143], v[192:195], v[72:75], v[128:143]
    ds_read_b64_tr_b16 v[208:209], v6 offset:61440
    ds_read_b64_tr_b16 v[210:211], v6 offset:62464
    ds_read_b64_tr_b16 v[212:213], v7 offset:61440
    ds_read_b64_tr_b16 v[214:215], v7 offset:62464
    v_mfma_f32_32x32x16_bf16 v[144:159], v[196:199], v[72:75], v[144:159]
    ds_read_b64_tr_b16 v[216:217], v8 offset:61440
    ds_read_b64_tr_b16 v[218:219], v8 offset:62464
    ds_read_b64_tr_b16 v[220:221], v10 offset:61440
    ds_read_b64_tr_b16 v[222:223], v10 offset:62464
    s_barrier
    v_mfma_f32_32x32x16_bf16 v[160:175], v[200:203], v[72:75], v[160:175]
    ds_read2st64_b32 v[80:81], v4 offset0:64 offset1:66
    ds_read2st64_b32 v[82:83], v4 offset0:68 offset1:70
    v_mfma_f32_32x32x16_bf16 v[176:191], v[204:207], v[72:75], v[176:191]
    ds_read2st64_b32 v[84:85], v4 offset0:80 offset1:82
    ds_read2st64_b32 v[86:87], v4 offset0:84 offset1:86
    s_waitcnt lgkmcnt(4)
    v_mfma_f32_32x32x16_bf16 v[128:143], v[208:211], v[76:79], v[128:143]
    ds_read_b64_tr_b16 v[192:193], v11 offset:0
    ds_read_b64_tr_b16 v[194:195], v11 offset:1024
    ds_read_b64_tr_b16 v[196:197], v12 offset:0
    ds_read_b64_tr_b16 v[198:199], v12 offset:1024
    v_mfma_f32_32x32x16_bf16 v[144:159], v[212:215], v[76:79], v[144:159]
    ds_read_b64_tr_b16 v[200:201], v13 offset:0
    ds_read_b64_tr_b16 v[202:203], v13 offset:1024
    ds_read_b64_tr_b16 v[204:205], v14 offset:0
    ds_read_b64_tr_b16 v[206:207], v14 offset:1024
    v_mfma_f32_32x32x16_bf16 v[160:175], v[216:219], v[76:79], v[160:175]
    s_add_u32 m0, s78, 8192
    s_mov_b32 s76, 1703936
    buffer_load_dwordx4 v2, s[48:51], s76 offen sc1 lds
    v_mfma_f32_32x32x16_bf16 v[176:191], v[220:223], v[76:79], v[176:191]
    buffer_load_dwordx4 v3, s[48:51], s76 offen offset:1024 sc1 lds
    s_waitcnt vmcnt(8) lgkmcnt(0)
    v_mfma_f32_32x32x16_bf16 v[128:143], v[192:195], v[80:83], v[128:143]
    ds_read_b64_tr_b16 v[208:209], v11 offset:4096
    ds_read_b64_tr_b16 v[210:211], v11 offset:5120
    ds_read_b64_tr_b16 v[212:213], v12 offset:4096
    ds_read_b64_tr_b16 v[214:215], v12 offset:5120
    v_mfma_f32_32x32x16_bf16 v[144:159], v[196:199], v[80:83], v[144:159]
    ds_read_b64_tr_b16 v[216:217], v13 offset:4096
    ds_read_b64_tr_b16 v[218:219], v13 offset:5120
    ds_read_b64_tr_b16 v[220:221], v14 offset:4096
    ds_read_b64_tr_b16 v[222:223], v14 offset:5120
    s_barrier
    v_mfma_f32_32x32x16_bf16 v[160:175], v[200:203], v[80:83], v[160:175]
    ds_read2st64_b32 v[88:89], v4 offset0:96 offset1:98
    ds_read2st64_b32 v[90:91], v4 offset0:100 offset1:102
    v_mfma_f32_32x32x16_bf16 v[176:191], v[204:207], v[80:83], v[176:191]
    ds_read2st64_b32 v[92:93], v4 offset0:112 offset1:114
    ds_read2st64_b32 v[94:95], v4 offset0:116 offset1:118
    s_waitcnt lgkmcnt(4)
    v_mfma_f32_32x32x16_bf16 v[128:143], v[208:211], v[84:87], v[128:143]
    ds_read_b64_tr_b16 v[192:193], v11 offset:8192
    ds_read_b64_tr_b16 v[194:195], v11 offset:9216
    ds_read_b64_tr_b16 v[196:197], v12 offset:8192
    ds_read_b64_tr_b16 v[198:199], v12 offset:9216
    v_mfma_f32_32x32x16_bf16 v[144:159], v[212:215], v[84:87], v[144:159]
    ds_read_b64_tr_b16 v[200:201], v13 offset:8192
    ds_read_b64_tr_b16 v[202:203], v13 offset:9216
    ds_read_b64_tr_b16 v[204:205], v14 offset:8192
    ds_read_b64_tr_b16 v[206:207], v14 offset:9216
    v_mfma_f32_32x32x16_bf16 v[160:175], v[216:219], v[84:87], v[160:175]
    global_store_dwordx4 v240, v[236:239], s[60:61] offset:0 sc1
    global_store_dwordx4 v240, v[236:239], s[60:61] offset:1024 sc1
    v_mfma_f32_32x32x16_bf16 v[176:191], v[220:223], v[84:87], v[176:191]
    global_store_dwordx4 v240, v[236:239], s[60:61] offset:2048 sc1
    global_store_dwordx4 v240, v[236:239], s[60:61] offset:3072 sc1
    s_waitcnt vmcnt(10) lgkmcnt(0)
    v_mfma_f32_32x32x16_bf16 v[128:143], v[192:195], v[88:91], v[128:143]
    ds_read_b64_tr_b16 v[208:209], v11 offset:12288
    ds_read_b64_tr_b16 v[210:211], v11 offset:13312
    ds_read_b64_tr_b16 v[212:213], v12 offset:12288
    ds_read_b64_tr_b16 v[214:215], v12 offset:13312
    v_mfma_f32_32x32x16_bf16 v[144:159], v[196:199], v[88:91], v[144:159]
    ds_read_b64_tr_b16 v[216:217], v13 offset:12288
    ds_read_b64_tr_b16 v[218:219], v13 offset:13312
    ds_read_b64_tr_b16 v[220:221], v14 offset:12288
    ds_read_b64_tr_b16 v[222:223], v14 offset:13312
    s_barrier
    v_mfma_f32_32x32x16_bf16 v[160:175], v[200:203], v[88:91], v[160:175]
    ds_read2st64_b32 v[96:97], v4 offset0:128 offset1:130
    ds_read2st64_b32 v[98:99], v4 offset0:132 offset1:134
    v_mfma_f32_32x32x16_bf16 v[176:191], v[204:207], v[88:91], v[176:191]
    ds_read2st64_b32 v[100:101], v4 offset0:144 offset1:146
    ds_read2st64_b32 v[102:103], v4 offset0:148 offset1:150
    s_waitcnt lgkmcnt(4)
    v_mfma_f32_32x32x16_bf16 v[128:143], v[208:211], v[92:95], v[128:143]
    ds_read_b64_tr_b16 v[192:193], v11 offset:16384
    ds_read_b64_tr_b16 v[194:195], v11 offset:17408
    ds_read_b64_tr_b16 v[196:197], v12 offset:16384
    ds_read_b64_tr_b16 v[198:199], v12 offset:17408
    v_mfma_f32_32x32x16_bf16 v[144:159], v[212:215], v[92:95], v[144:159]
    ds_read_b64_tr_b16 v[200:201], v13 offset:16384
    ds_read_b64_tr_b16 v[202:203], v13 offset:17408
    ds_read_b64_tr_b16 v[204:205], v14 offset:16384
    ds_read_b64_tr_b16 v[206:207], v14 offset:17408
    v_mfma_f32_32x32x16_bf16 v[160:175], v[216:219], v[92:95], v[160:175]
    global_store_dwordx4 v241, v[236:239], s[60:61] offset:0 sc1
    global_store_dwordx4 v241, v[236:239], s[60:61] offset:1024 sc1
    v_mfma_f32_32x32x16_bf16 v[176:191], v[220:223], v[92:95], v[176:191]
    global_store_dwordx4 v241, v[236:239], s[60:61] offset:2048 sc1
    global_store_dwordx4 v241, v[236:239], s[60:61] offset:3072 sc1
    s_waitcnt vmcnt(12) lgkmcnt(0)
    v_mfma_f32_32x32x16_bf16 v[128:143], v[192:195], v[96:99], v[128:143]
    ds_read_b64_tr_b16 v[208:209], v11 offset:20480
    ds_read_b64_tr_b16 v[210:211], v11 offset:21504
    ds_read_b64_tr_b16 v[212:213], v12 offset:20480
    ds_read_b64_tr_b16 v[214:215], v12 offset:21504
    v_mfma_f32_32x32x16_bf16 v[144:159], v[196:199], v[96:99], v[144:159]
    ds_read_b64_tr_b16 v[216:217], v13 offset:20480
    ds_read_b64_tr_b16 v[218:219], v13 offset:21504
    ds_read_b64_tr_b16 v[220:221], v14 offset:20480
    ds_read_b64_tr_b16 v[222:223], v14 offset:21504
    s_barrier
    v_mfma_f32_32x32x16_bf16 v[160:175], v[200:203], v[96:99], v[160:175]
    ds_read2st64_b32 v[104:105], v4 offset0:160 offset1:162
    ds_read2st64_b32 v[106:107], v4 offset0:164 offset1:166
    v_mfma_f32_32x32x16_bf16 v[176:191], v[204:207], v[96:99], v[176:191]
    ds_read2st64_b32 v[108:109], v4 offset0:176 offset1:178
    ds_read2st64_b32 v[110:111], v4 offset0:180 offset1:182
    s_waitcnt lgkmcnt(4)
    v_mfma_f32_32x32x16_bf16 v[128:143], v[208:211], v[100:103], v[128:143]
    ds_read_b64_tr_b16 v[192:193], v11 offset:24576
    ds_read_b64_tr_b16 v[194:195], v11 offset:25600
    ds_read_b64_tr_b16 v[196:197], v12 offset:24576
    ds_read_b64_tr_b16 v[198:199], v12 offset:25600
    v_mfma_f32_32x32x16_bf16 v[144:159], v[212:215], v[100:103], v[144:159]
    ds_read_b64_tr_b16 v[200:201], v13 offset:24576
    ds_read_b64_tr_b16 v[202:203], v13 offset:25600
    ds_read_b64_tr_b16 v[204:205], v14 offset:24576
    ds_read_b64_tr_b16 v[206:207], v14 offset:25600
    v_mfma_f32_32x32x16_bf16 v[160:175], v[216:219], v[100:103], v[160:175]
    v_mfma_f32_32x32x16_bf16 v[176:191], v[220:223], v[100:103], v[176:191]
    s_waitcnt vmcnt(10) lgkmcnt(0)
    v_mfma_f32_32x32x16_bf16 v[128:143], v[192:195], v[104:107], v[128:143]
    ds_read_b64_tr_b16 v[208:209], v11 offset:28672
    ds_read_b64_tr_b16 v[210:211], v11 offset:29696
    ds_read_b64_tr_b16 v[212:213], v12 offset:28672
    ds_read_b64_tr_b16 v[214:215], v12 offset:29696
    v_mfma_f32_32x32x16_bf16 v[144:159], v[196:199], v[104:107], v[144:159]
    ds_read_b64_tr_b16 v[216:217], v13 offset:28672
    ds_read_b64_tr_b16 v[218:219], v13 offset:29696
    ds_read_b64_tr_b16 v[220:221], v14 offset:28672
    ds_read_b64_tr_b16 v[222:223], v14 offset:29696
    s_barrier
    v_mfma_f32_32x32x16_bf16 v[160:175], v[200:203], v[104:107], v[160:175]
    ds_read2st64_b32 v[112:113], v4 offset0:0 offset1:2
    ds_read2st64_b32 v[114:115], v4 offset0:4 offset1:6
    v_mfma_f32_32x32x16_bf16 v[176:191], v[204:207], v[104:107], v[176:191]
    ds_read2st64_b32 v[116:117], v4 offset0:16 offset1:18
    ds_read2st64_b32 v[118:119], v4 offset0:20 offset1:22
    s_waitcnt lgkmcnt(4)
    v_mfma_f32_32x32x16_bf16 v[128:143], v[208:211], v[108:111], v[128:143]
    ds_read_b64_tr_b16 v[192:193], v11 offset:32768
    ds_read_b64_tr_b16 v[194:195], v11 offset:33792
    ds_read_b64_tr_b16 v[196:197], v12 offset:32768
    ds_read_b64_tr_b16 v[198:199], v12 offset:33792
    v_mfma_f32_32x32x16_bf16 v[144:159], v[212:215], v[108:111], v[144:159]
    ds_read_b64_tr_b16 v[200:201], v13 offset:32768
    ds_read_b64_tr_b16 v[202:203], v13 offset:33792
    ds_read_b64_tr_b16 v[204:205], v14 offset:32768
    ds_read_b64_tr_b16 v[206:207], v14 offset:33792
    v_mfma_f32_32x32x16_bf16 v[160:175], v[216:219], v[108:111], v[160:175]
    v_mfma_f32_32x32x16_bf16 v[176:191], v[220:223], v[108:111], v[176:191]
    s_waitcnt vmcnt(8) lgkmcnt(0)
    v_mfma_f32_32x32x16_bf16 v[128:143], v[192:195], v[112:115], v[128:143]
    ds_read_b64_tr_b16 v[208:209], v11 offset:36864
    ds_read_b64_tr_b16 v[210:211], v11 offset:37888
    ds_read_b64_tr_b16 v[212:213], v12 offset:36864
    ds_read_b64_tr_b16 v[214:215], v12 offset:37888
    v_mfma_f32_32x32x16_bf16 v[144:159], v[196:199], v[112:115], v[144:159]
    ds_read_b64_tr_b16 v[216:217], v13 offset:36864
    ds_read_b64_tr_b16 v[218:219], v13 offset:37888
    ds_read_b64_tr_b16 v[220:221], v14 offset:36864
    ds_read_b64_tr_b16 v[222:223], v14 offset:37888
    s_barrier
    v_mfma_f32_32x32x16_bf16 v[160:175], v[200:203], v[112:115], v[160:175]
    ds_read2st64_b32 v[120:121], v4 offset0:32 offset1:34
    ds_read2st64_b32 v[122:123], v4 offset0:36 offset1:38
    v_mfma_f32_32x32x16_bf16 v[176:191], v[204:207], v[112:115], v[176:191]
    ds_read2st64_b32 v[124:125], v4 offset0:48 offset1:50
    ds_read2st64_b32 v[126:127], v4 offset0:52 offset1:54
    s_waitcnt lgkmcnt(4)
    v_mfma_f32_32x32x16_bf16 v[128:143], v[208:211], v[116:119], v[128:143]
    ds_read_b64_tr_b16 v[192:193], v11 offset:40960
    ds_read_b64_tr_b16 v[194:195], v11 offset:41984
    ds_read_b64_tr_b16 v[196:197], v12 offset:40960
    ds_read_b64_tr_b16 v[198:199], v12 offset:41984
    v_mfma_f32_32x32x16_bf16 v[144:159], v[212:215], v[116:119], v[144:159]
    ds_read_b64_tr_b16 v[200:201], v13 offset:40960
    ds_read_b64_tr_b16 v[202:203], v13 offset:41984
    ds_read_b64_tr_b16 v[204:205], v14 offset:40960
    ds_read_b64_tr_b16 v[206:207], v14 offset:41984
    v_mfma_f32_32x32x16_bf16 v[160:175], v[216:219], v[116:119], v[160:175]
    v_mfma_f32_32x32x16_bf16 v[176:191], v[220:223], v[116:119], v[176:191]
    s_waitcnt lgkmcnt(0)
    v_mfma_f32_32x32x16_bf16 v[128:143], v[192:195], v[120:123], v[128:143]
    ds_read_b64_tr_b16 v[208:209], v11 offset:45056
    ds_read_b64_tr_b16 v[210:211], v11 offset:46080
    ds_read_b64_tr_b16 v[212:213], v12 offset:45056
    ds_read_b64_tr_b16 v[214:215], v12 offset:46080
    v_mfma_f32_32x32x16_bf16 v[144:159], v[196:199], v[120:123], v[144:159]
    ds_read_b64_tr_b16 v[216:217], v13 offset:45056
    ds_read_b64_tr_b16 v[218:219], v13 offset:46080
    ds_read_b64_tr_b16 v[220:221], v14 offset:45056
    ds_read_b64_tr_b16 v[222:223], v14 offset:46080
    v_mfma_f32_32x32x16_bf16 v[160:175], v[200:203], v[120:123], v[160:175]
    v_mfma_f32_32x32x16_bf16 v[176:191], v[204:207], v[120:123], v[176:191]
    s_waitcnt lgkmcnt(0)
    v_mfma_f32_32x32x16_bf16 v[128:143], v[208:211], v[124:127], v[128:143]
    v_mfma_f32_32x32x16_bf16 v[144:159], v[212:215], v[124:127], v[144:159]
    v_mfma_f32_32x32x16_bf16 v[160:175], v[216:219], v[124:127], v[160:175]
    v_mfma_f32_32x32x16_bf16 v[176:191], v[220:223], v[124:127], v[176:191]
    v_dot2_f32_bf16 v232, v16, s73, 0
    v_dot2_f32_bf16 v234, v16, v16, 0
    v_dot2_f32_bf16 v233, v17, s73, 0
    v_dot2_f32_bf16 v235, v17, v17, 0
    v_dot2_f32_bf16 v232, v18, s73, v232
    v_dot2_f32_bf16 v234, v18, v18, v234
    v_dot2_f32_bf16 v233, v19, s73, v233
    v_dot2_f32_bf16 v235, v19, v19, v235
    v_dot2_f32_bf16 v232, v20, s73, v232
    v_dot2_f32_bf16 v234, v20, v20, v234
    v_dot2_f32_bf16 v233, v21, s73, v233
    v_dot2_f32_bf16 v235, v21, v21, v235
    v_dot2_f32_bf16 v232, v22, s73, v232
    v_dot2_f32_bf16 v234, v22, v22, v234
    v_dot2_f32_bf16 v233, v23, s73, v233
    v_dot2_f32_bf16 v235, v23, v23, v235
    v_dot2_f32_bf16 v232, v24, s73, v232
    v_dot2_f32_bf16 v234, v24, v24, v234
    v_dot2_f32_bf16 v233, v25, s73, v233
    v_dot2_f32_bf16 v235, v25, v25, v235
    v_dot2_f32_bf16 v232, v26, s73, v232
    v_dot2_f32_bf16 v234, v26, v26, v234
    v_dot2_f32_bf16 v233, v27, s73, v233
    v_dot2_f32_bf16 v235, v27, v27, v235
    v_dot2_f32_bf16 v232, v28, s73, v232
    v_dot2_f32_bf16 v234, v28, v28, v234
    v_dot2_f32_bf16 v233, v29, s73, v233
    v_dot2_f32_bf16 v235, v29, v29, v235
    v_dot2_f32_bf16 v232, v30, s73, v232
    v_dot2_f32_bf16 v234, v30, v30, v234
    v_dot2_f32_bf16 v233, v31, s73, v233
    v_dot2_f32_bf16 v235, v31, v31, v235
    v_dot2_f32_bf16 v232, v32, s73, v232
    v_dot2_f32_bf16 v234, v32, v32, v234
    v_dot2_f32_bf16 v233, v33, s73, v233
    v_dot2_f32_bf16 v235, v33, v33, v235
    v_dot2_f32_bf16 v232, v34, s73, v232
    v_dot2_f32_bf16 v234, v34, v34, v234
    v_dot2_f32_bf16 v233, v35, s73, v233
    v_dot2_f32_bf16 v235, v35, v35, v235
    v_dot2_f32_bf16 v232, v36, s73, v232
    v_dot2_f32_bf16 v234, v36, v36, v234
    v_dot2_f32_bf16 v233, v37, s73, v233
    v_dot2_f32_bf16 v235, v37, v37, v235
    v_dot2_f32_bf16 v232, v38, s73, v232
    v_dot2_f32_bf16 v234, v38, v38, v234
    v_dot2_f32_bf16 v233, v39, s73, v233
    v_dot2_f32_bf16 v235, v39, v39, v235
    v_dot2_f32_bf16 v232, v40, s73, v232
    v_dot2_f32_bf16 v234, v40, v40, v234
    v_dot2_f32_bf16 v233, v41, s73, v233
    v_dot2_f32_bf16 v235, v41, v41, v235
    v_dot2_f32_bf16 v232, v42, s73, v232
    v_dot2_f32_bf16 v234, v42, v42, v234
    v_dot2_f32_bf16 v233, v43, s73, v233
    v_dot2_f32_bf16 v235, v43, v43, v235
    v_dot2_f32_bf16 v232, v44, s73, v232
    v_dot2_f32_bf16 v234, v44, v44, v234
    v_dot2_f32_bf16 v233, v45, s73, v233
    v_dot2_f32_bf16 v235, v45, v45, v235
    v_dot2_f32_bf16 v232, v46, s73, v232
    v_dot2_f32_bf16 v234, v46, v46, v234
    v_dot2_f32_bf16 v233, v47, s73, v233
    v_dot2_f32_bf16 v235, v47, v47, v235
    v_dot2_f32_bf16 v232, v48, s73, v232
    v_dot2_f32_bf16 v234, v48, v48, v234
    v_dot2_f32_bf16 v233, v49, s73, v233
    v_dot2_f32_bf16 v235, v49, v49, v235
    v_dot2_f32_bf16 v232, v50, s73, v232
    v_dot2_f32_bf16 v234, v50, v50, v234
    v_dot2_f32_bf16 v233, v51, s73, v233
    v_dot2_f32_bf16 v235, v51, v51, v235
    v_dot2_f32_bf16 v232, v52, s73, v232
    v_dot2_f32_bf16 v234, v52, v52, v234
    v_dot2_f32_bf16 v233, v53, s73, v233
    v_dot2_f32_bf16 v235, v53, v53, v235
    v_dot2_f32_bf16 v232, v54, s73, v232
    v_dot2_f32_bf16 v234, v54, v54, v234
    v_dot2_f32_bf16 v233, v55, s73, v233
    v_dot2_f32_bf16 v235, v55, v55, v235
    v_dot2_f32_bf16 v232, v56, s73, v232
    v_dot2_f32_bf16 v234, v56, v56, v234
    v_dot2_f32_bf16 v233, v57, s73, v233
    v_dot2_f32_bf16 v235, v57, v57, v235
    v_dot2_f32_bf16 v232, v58, s73, v232
    v_dot2_f32_bf16 v234, v58, v58, v234
    v_dot2_f32_bf16 v233, v59, s73, v233
    v_dot2_f32_bf16 v235, v59, v59, v235
    v_dot2_f32_bf16 v232, v60, s73, v232
    v_dot2_f32_bf16 v234, v60, v60, v234
    v_dot2_f32_bf16 v233, v61, s73, v233
    v_dot2_f32_bf16 v235, v61, v61, v235
    v_dot2_f32_bf16 v232, v62, s73, v232
    v_dot2_f32_bf16 v234, v62, v62, v234
    v_dot2_f32_bf16 v233, v63, s73, v233
    v_dot2_f32_bf16 v235, v63, v63, v235
    v_dot2_f32_bf16 v232, v64, s73, v232
    v_dot2_f32_bf16 v234, v64, v64, v234
    v_dot2_f32_bf16 v233, v65, s73, v233
    v_dot2_f32_bf16 v235, v65, v65, v235
    v_dot2_f32_bf16 v232, v66, s73, v232
    v_dot2_f32_bf16 v234, v66, v66, v234
    v_dot2_f32_bf16 v233, v67, s73, v233
    v_dot2_f32_bf16 v235, v67, v67, v235
    v_dot2_f32_bf16 v232, v68, s73, v232
    v_dot2_f32_bf16 v234, v68, v68, v234
    v_dot2_f32_bf16 v233, v69, s73, v233
    v_dot2_f32_bf16 v235, v69, v69, v235
    v_dot2_f32_bf16 v232, v70, s73, v232
    v_dot2_f32_bf16 v234, v70, v70, v234
    v_dot2_f32_bf16 v233, v71, s73, v233
    v_dot2_f32_bf16 v235, v71, v71, v235
    v_dot2_f32_bf16 v232, v72, s73, v232
    v_dot2_f32_bf16 v234, v72, v72, v234
    v_dot2_f32_bf16 v233, v73, s73, v233
    v_dot2_f32_bf16 v235, v73, v73, v235
    v_dot2_f32_bf16 v232, v74, s73, v232
    v_dot2_f32_bf16 v234, v74, v74, v234
    v_dot2_f32_bf16 v233, v75, s73, v233
    v_dot2_f32_bf16 v235, v75, v75, v235
    v_dot2_f32_bf16 v232, v76, s73, v232
    v_dot2_f32_bf16 v234, v76, v76, v234
    v_dot2_f32_bf16 v233, v77, s73, v233
    v_dot2_f32_bf16 v235, v77, v77, v235
    v_dot2_f32_bf16 v232, v78, s73, v232
    v_dot2_f32_bf16 v234, v78, v78, v234
    v_dot2_f32_bf16 v233, v79, s73, v233
    v_dot2_f32_bf16 v235, v79, v79, v235
    v_dot2_f32_bf16 v232, v80, s73, v232
    v_dot2_f32_bf16 v234, v80, v80, v234
    v_dot2_f32_bf16 v233, v81, s73, v233
    v_dot2_f32_bf16 v235, v81, v81, v235
    v_dot2_f32_bf16 v232, v82, s73, v232
    v_dot2_f32_bf16 v234, v82, v82, v234
    v_dot2_f32_bf16 v233, v83, s73, v233
    v_dot2_f32_bf16 v235, v83, v83, v235
    v_dot2_f32_bf16 v232, v84, s73, v232
    v_dot2_f32_bf16 v234, v84, v84, v234
    v_dot2_f32_bf16 v233, v85, s73, v233
    v_dot2_f32_bf16 v235, v85, v85, v235
    v_dot2_f32_bf16 v232, v86, s73, v232
    v_dot2_f32_bf16 v234, v86, v86, v234
    v_dot2_f32_bf16 v233, v87, s73, v233
    v_dot2_f32_bf16 v235, v87, v87, v235
    v_dot2_f32_bf16 v232, v88, s73, v232
    v_dot2_f32_bf16 v234, v88, v88, v234
    v_dot2_f32_bf16 v233, v89, s73, v233
    v_dot2_f32_bf16 v235, v89, v89, v235
    v_dot2_f32_bf16 v232, v90, s73, v232
    v_dot2_f32_bf16 v234, v90, v90, v234
    v_dot2_f32_bf16 v233, v91, s73, v233
    v_dot2_f32_bf16 v235, v91, v91, v235
    v_dot2_f32_bf16 v232, v92, s73, v232
    v_dot2_f32_bf16 v234, v92, v92, v234
    v_dot2_f32_bf16 v233, v93, s73, v233
    v_dot2_f32_bf16 v235, v93, v93, v235
    v_dot2_f32_bf16 v232, v94, s73, v232
    v_dot2_f32_bf16 v234, v94, v94, v234
    v_dot2_f32_bf16 v233, v95, s73, v233
    v_dot2_f32_bf16 v235, v95, v95, v235
    v_dot2_f32_bf16 v232, v96, s73, v232
    v_dot2_f32_bf16 v234, v96, v96, v234
    v_dot2_f32_bf16 v233, v97, s73, v233
    v_dot2_f32_bf16 v235, v97, v97, v235
    v_dot2_f32_bf16 v232, v98, s73, v232
    v_dot2_f32_bf16 v234, v98, v98, v234
    v_dot2_f32_bf16 v233, v99, s73, v233
    v_dot2_f32_bf16 v235, v99, v99, v235
    v_dot2_f32_bf16 v232, v100, s73, v232
    v_dot2_f32_bf16 v234, v100, v100, v234
    v_dot2_f32_bf16 v233, v101, s73, v233
    v_dot2_f32_bf16 v235, v101, v101, v235
    v_dot2_f32_bf16 v232, v102, s73, v232
    v_dot2_f32_bf16 v234, v102, v102, v234
    v_dot2_f32_bf16 v233, v103, s73, v233
    v_dot2_f32_bf16 v235, v103, v103, v235
    v_dot2_f32_bf16 v232, v104, s73, v232
    v_dot2_f32_bf16 v234, v104, v104, v234
    v_dot2_f32_bf16 v233, v105, s73, v233
    v_dot2_f32_bf16 v235, v105, v105, v235
    v_dot2_f32_bf16 v232, v106, s73, v232
    v_dot2_f32_bf16 v234, v106, v106, v234
    v_dot2_f32_bf16 v233, v107, s73, v233
    v_dot2_f32_bf16 v235, v107, v107, v235
    v_dot2_f32_bf16 v232, v108, s73, v232
    v_dot2_f32_bf16 v234, v108, v108, v234
    v_dot2_f32_bf16 v233, v109, s73, v233
    v_dot2_f32_bf16 v235, v109, v109, v235
    v_dot2_f32_bf16 v232, v110, s73, v232
    v_dot2_f32_bf16 v234, v110, v110, v234
    v_dot2_f32_bf16 v233, v111, s73, v233
    v_dot2_f32_bf16 v235, v111, v111, v235
    v_dot2_f32_bf16 v232, v112, s73, v232
    v_dot2_f32_bf16 v234, v112, v112, v234
    v_dot2_f32_bf16 v233, v113, s73, v233
    v_dot2_f32_bf16 v235, v113, v113, v235
    v_dot2_f32_bf16 v232, v114, s73, v232
    v_dot2_f32_bf16 v234, v114, v114, v234
    v_dot2_f32_bf16 v233, v115, s73, v233
    v_dot2_f32_bf16 v235, v115, v115, v235
    v_dot2_f32_bf16 v232, v116, s73, v232
    v_dot2_f32_bf16 v234, v116, v116, v234
    v_dot2_f32_bf16 v233, v117, s73, v233
    v_dot2_f32_bf16 v235, v117, v117, v235
    v_dot2_f32_bf16 v232, v118, s73, v232
    v_dot2_f32_bf16 v234, v118, v118, v234
    v_dot2_f32_bf16 v233, v119, s73, v233
    v_dot2_f32_bf16 v235, v119, v119, v235
    v_dot2_f32_bf16 v232, v120, s73, v232
    v_dot2_f32_bf16 v234, v120, v120, v234
    v_dot2_f32_bf16 v233, v121, s73, v233
    v_dot2_f32_bf16 v235, v121, v121, v235
    v_dot2_f32_bf16 v232, v122, s73, v232
    v_dot2_f32_bf16 v234, v122, v122, v234
    v_dot2_f32_bf16 v233, v123, s73, v233
    v_dot2_f32_bf16 v235, v123, v123, v235
    v_dot2_f32_bf16 v232, v124, s73, v232
    v_dot2_f32_bf16 v234, v124, v124, v234
    v_dot2_f32_bf16 v233, v125, s73, v233
    v_dot2_f32_bf16 v235, v125, v125, v235
    v_dot2_f32_bf16 v232, v126, s73, v232
    v_dot2_f32_bf16 v234, v126, v126, v234
    v_dot2_f32_bf16 v233, v127, s73, v233
    v_dot2_f32_bf16 v235, v127, v127, v235
    s_waitcnt vmcnt(0)
    s_barrier
    s_cmp_lg_u32 s3, 0
    s_cbranch_scc1 s3w0_44
    s_add_u32 s66, s38, 32
    s_lshl_b32 s67, s66, 7
    v_mov_b32 v245, s67
    v_mov_b32 v246, 1
    s_mov_b64 s[64:65], exec
    s_mov_b64 exec, 1
    global_atomic_add v245, v246, s[34:35] sc1
    s_mov_b64 exec, s[64:65]
s3w0_44:
    s_nop 1
    v_add_f32 v232, v232, v233
    v_add_f32 v234, v234, v235
    v_mov_b32 v233, v232
    v_mov_b32 v235, v234
    v_lshlrev_b32 v9, 4, v1
    s_nop 0
    v_permlane32_swap_b32 v232, v233
    v_permlane32_swap_b32 v234, v235
    s_mov_b32 s66, 0x3b124925
    s_nop 0
    v_add_f32 v232, v232, v233
    v_add_f32 v234, v234, v235
    v_mul_f32 v232, s66, v232
    v_mul_f32 v234, s66, v234
    v_fma_f32 v234, -v232, v232, v234
    v_add_f32 v234, 0x3727c5ac, v234
    v_rsq_f32 v235, v234
    v_sqrt_f32 v230, v234
    s_mov_b32 s66, 0xc0135761
    s_mov_b32 s67, 0xbdd2d3e8
    v_mul_f32 v229, s66, v235
    v_mul_f32 v228, v235, v235
    v_mul_f32 v228, v228, v235
    v_mul_f32 v228, s67, v228
    v_cvt_pk_bf16_f32 v233, v232, v232
    v_and_b32 v231, s72, v233
    v_sub_f32 v231, v232, v231
    v_cvt_pk_bf16_f32 v236, v230, v230
    v_and_b32 v237, s72, v236
    v_sub_f32 v237, v230, v237
    v_and_b32 v225, s72, v236
    v_cvt_pk_bf16_f32 v231, v231, v231
    v_and_b32 v231, 0xffff, v231
    v_or_b32 v225, v225, v231
    v_cvt_pk_bf16_f32 v226, v237, 0
    v_mov_b32 v224, v233
    v_mov_b32 v227, 0
    v_cmp_gt_u32 vcc, 32, v1
    s_lshl_b32 s66, s38, 2
    s_add_u32 s66, s66, s3
    v_cndmask_b32 v224, 0, v224, vcc
    v_cndmask_b32 v225, 0, v225, vcc
    v_cndmask_b32 v226, 0, v226, vcc
    s_mul_i32 s66, s66, 56
    s_lshl_b32 s67, s39, 2
    v_mfma_f32_32x32x16_bf16 v[128:143], a[224:227], v[224:227], v[128:143]
    v_mfma_f32_32x32x16_bf16 v[144:159], a[228:231], v[224:227], v[144:159]
    v_mfma_f32_32x32x16_bf16 v[160:175], a[232:235], v[224:227], v[160:175]
    v_mfma_f32_32x32x16_bf16 v[176:191], a[236:239], v[224:227], v[176:191]
    s_add_u32 s66, s66, s67
    s_lshl_b32 s66, s66, 11
    v_lshl_add_u32 v8, v1, 4, s66
    v_add_u32 v11, 4096, v8
    s_nop 7
    v_pk_mul_f32 v[236:237], v[128:129], v[128:129]
    v_pk_mul_f32 v[238:239], v[130:131], v[130:131]
    v_pk_mul_f32 v[240:241], v[132:133], v[132:133]
    v_pk_mul_f32 v[242:243], v[134:135], v[134:135]
    v_pk_fma_f32 v[236:237], v[236:237], v[228:229], v[228:229] op_sel:[0,0,1] op_sel_hi:[1,0,1]
    v_pk_fma_f32 v[238:239], v[238:239], v[228:229], v[228:229] op_sel:[0,0,1] op_sel_hi:[1,0,1]
    v_pk_fma_f32 v[240:241], v[240:241], v[228:229], v[228:229] op_sel:[0,0,1] op_sel_hi:[1,0,1]
    v_pk_fma_f32 v[242:243], v[242:243], v[228:229], v[228:229] op_sel:[0,0,1] op_sel_hi:[1,0,1]
    v_pk_mul_f32 v[236:237], v[236:237], v[128:129]
    v_pk_mul_f32 v[238:239], v[238:239], v[130:131]
    v_pk_mul_f32 v[240:241], v[240:241], v[132:133]
    v_pk_mul_f32 v[242:243], v[242:243], v[134:135]
    v_exp_f32 v236, v236
    v_exp_f32 v237, v237
    v_exp_f32 v238, v238
    v_exp_f32 v239, v239
    v_exp_f32 v240, v240
    v_exp_f32 v241, v241
    v_exp_f32 v242, v242
    v_exp_f32 v243, v243
    v_pk_fma_f32 v[236:237], v[236:237], v[230:231], v[230:231] op_sel_hi:[1,0,0]
    v_pk_fma_f32 v[238:239], v[238:239], v[230:231], v[230:231] op_sel_hi:[1,0,0]
    v_pk_fma_f32 v[240:241], v[240:241], v[230:231], v[230:231] op_sel_hi:[1,0,0]
    v_pk_fma_f32 v[242:243], v[242:243], v[230:231], v[230:231] op_sel_hi:[1,0,0]
    v_rcp_f32 v236, v236
    v_rcp_f32 v237, v237
    v_rcp_f32 v238, v238
    v_rcp_f32 v239, v239
    v_rcp_f32 v240, v240
    v_rcp_f32 v241, v241
    v_rcp_f32 v242, v242
    v_rcp_f32 v243, v243
    v_pk_mul_f32 v[128:129], v[128:129], v[236:237]
    v_pk_mul_f32 v[130:131], v[130:131], v[238:239]
    v_pk_mul_f32 v[132:133], v[132:133], v[240:241]
    v_pk_mul_f32 v[134:135], v[134:135], v[242:243]
    v_pk_mul_f32 v[236:237], v[136:137], v[136:137]
    v_pk_mul_f32 v[238:239], v[138:139], v[138:139]
    v_pk_mul_f32 v[240:241], v[140:141], v[140:141]
    v_pk_mul_f32 v[242:243], v[142:143], v[142:143]
    v_pk_fma_f32 v[236:237], v[236:237], v[228:229], v[228:229] op_sel:[0,0,1] op_sel_hi:[1,0,1]
    v_pk_fma_f32 v[238:239], v[238:239], v[228:229], v[228:229] op_sel:[0,0,1] op_sel_hi:[1,0,1]
    v_pk_fma_f32 v[240:241], v[240:241], v[228:229], v[228:229] op_sel:[0,0,1] op_sel_hi:[1,0,1]
    v_pk_fma_f32 v[242:243], v[242:243], v[228:229], v[228:229] op_sel:[0,0,1] op_sel_hi:[1,0,1]
    v_pk_mul_f32 v[236:237], v[236:237], v[136:137]
    v_pk_mul_f32 v[238:239], v[238:239], v[138:139]
    v_pk_mul_f32 v[240:241], v[240:241], v[140:141]
    v_pk_mul_f32 v[242:243], v[242:243], v[142:143]
    v_exp_f32 v236, v236
    v_exp_f32 v237, v237
    v_exp_f32 v238, v238
    v_exp_f32 v239, v239
    v_exp_f32 v240, v240
    v_exp_f32 v241, v241
    v_exp_f32 v242, v242
    v_exp_f32 v243, v243
    v_pk_fma_f32 v[236:237], v[236:237], v[230:231], v[230:231] op_sel_hi:[1,0,0]
    v_pk_fma_f32 v[238:239], v[238:239], v[230:231], v[230:231] op_sel_hi:[1,0,0]
    v_pk_fma_f32 v[240:241], v[240:241], v[230:231], v[230:231] op_sel_hi:[1,0,0]
    v_pk_fma_f32 v[242:243], v[242:243], v[230:231], v[230:231] op_sel_hi:[1,0,0]
    v_rcp_f32 v236, v236
    v_rcp_f32 v237, v237
    v_rcp_f32 v238, v238
    v_rcp_f32 v239, v239
    v_rcp_f32 v240, v240
    v_rcp_f32 v241, v241
    v_rcp_f32 v242, v242
    v_rcp_f32 v243, v243
    v_pk_mul_f32 v[136:137], v[136:137], v[236:237]
    v_pk_mul_f32 v[138:139], v[138:139], v[238:239]
    v_pk_mul_f32 v[140:141], v[140:141], v[240:241]
    v_pk_mul_f32 v[142:143], v[142:143], v[242:243]
    v_cvt_pk_bf16_f32 v192, v128, v129
    v_cvt_pk_bf16_f32 v193, v130, v131
    v_cvt_pk_bf16_f32 v194, v132, v133
    v_cvt_pk_bf16_f32 v195, v134, v135
    v_cvt_pk_bf16_f32 v196, v136, v137
    v_cvt_pk_bf16_f32 v197, v138, v139
    v_cvt_pk_bf16_f32 v198, v140, v141
    v_cvt_pk_bf16_f32 v199, v142, v143
    global_store_dwordx4 v8, v[192:195], s[60:61] offset:0 sc1
    global_store_dwordx4 v8, v[196:199], s[60:61] offset:1024 sc1
    v_pk_mul_f32 v[236:237], v[144:145], v[144:145]
    v_pk_mul_f32 v[238:239], v[146:147], v[146:147]
    v_pk_mul_f32 v[240:241], v[148:149], v[148:149]
    v_pk_mul_f32 v[242:243], v[150:151], v[150:151]
    v_pk_fma_f32 v[236:237], v[236:237], v[228:229], v[228:229] op_sel:[0,0,1] op_sel_hi:[1,0,1]
    v_pk_fma_f32 v[238:239], v[238:239], v[228:229], v[228:229] op_sel:[0,0,1] op_sel_hi:[1,0,1]
    v_pk_fma_f32 v[240:241], v[240:241], v[228:229], v[228:229] op_sel:[0,0,1] op_sel_hi:[1,0,1]
    v_pk_fma_f32 v[242:243], v[242:243], v[228:229], v[228:229] op_sel:[0,0,1] op_sel_hi:[1,0,1]
    v_pk_mul_f32 v[236:237], v[236:237], v[144:145]
    v_pk_mul_f32 v[238:239], v[238:239], v[146:147]
    v_pk_mul_f32 v[240:241], v[240:241], v[148:149]
    v_pk_mul_f32 v[242:243], v[242:243], v[150:151]
    v_exp_f32 v236, v236
    v_exp_f32 v237, v237
    v_exp_f32 v238, v238
    v_exp_f32 v239, v239
    v_exp_f32 v240, v240
    v_exp_f32 v241, v241
    v_exp_f32 v242, v242
    v_exp_f32 v243, v243
    v_pk_fma_f32 v[236:237], v[236:237], v[230:231], v[230:231] op_sel_hi:[1,0,0]
    v_pk_fma_f32 v[238:239], v[238:239], v[230:231], v[230:231] op_sel_hi:[1,0,0]
    v_pk_fma_f32 v[240:241], v[240:241], v[230:231], v[230:231] op_sel_hi:[1,0,0]
    v_pk_fma_f32 v[242:243], v[242:243], v[230:231], v[230:231] op_sel_hi:[1,0,0]
    v_rcp_f32 v236, v236
    v_rcp_f32 v237, v237
    v_rcp_f32 v238, v238
    v_rcp_f32 v239, v239
    v_rcp_f32 v240, v240
    v_rcp_f32 v241, v241
    v_rcp_f32 v242, v242
    v_rcp_f32 v243, v243
    v_pk_mul_f32 v[144:145], v[144:145], v[236:237]
    v_pk_mul_f32 v[146:147], v[146:147], v[238:239]
    v_pk_mul_f32 v[148:149], v[148:149], v[240:241]
    v_pk_mul_f32 v[150:151], v[150:151], v[242:243]
    v_pk_mul_f32 v[236:237], v[152:153], v[152:153]
    v_pk_mul_f32 v[238:239], v[154:155], v[154:155]
    v_pk_mul_f32 v[240:241], v[156:157], v[156:157]
    v_pk_mul_f32 v[242:243], v[158:159], v[158:159]
    v_pk_fma_f32 v[236:237], v[236:237], v[228:229], v[228:229] op_sel:[0,0,1] op_sel_hi:[1,0,1]
    v_pk_fma_f32 v[238:239], v[238:239], v[228:229], v[228:229] op_sel:[0,0,1] op_sel_hi:[1,0,1]
    v_pk_fma_f32 v[240:241], v[240:241], v[228:229], v[228:229] op_sel:[0,0,1] op_sel_hi:[1,0,1]
    v_pk_fma_f32 v[242:243], v[242:243], v[228:229], v[228:229] op_sel:[0,0,1] op_sel_hi:[1,0,1]
    v_pk_mul_f32 v[236:237], v[236:237], v[152:153]
    v_pk_mul_f32 v[238:239], v[238:239], v[154:155]
    v_pk_mul_f32 v[240:241], v[240:241], v[156:157]
    v_pk_mul_f32 v[242:243], v[242:243], v[158:159]
    v_exp_f32 v236, v236
    v_exp_f32 v237, v237
    v_exp_f32 v238, v238
    v_exp_f32 v239, v239
    v_exp_f32 v240, v240
    v_exp_f32 v241, v241
    v_exp_f32 v242, v242
    v_exp_f32 v243, v243
    v_pk_fma_f32 v[236:237], v[236:237], v[230:231], v[230:231] op_sel_hi:[1,0,0]
    v_pk_fma_f32 v[238:239], v[238:239], v[230:231], v[230:231] op_sel_hi:[1,0,0]
    v_pk_fma_f32 v[240:241], v[240:241], v[230:231], v[230:231] op_sel_hi:[1,0,0]
    v_pk_fma_f32 v[242:243], v[242:243], v[230:231], v[230:231] op_sel_hi:[1,0,0]
    v_rcp_f32 v236, v236
    v_rcp_f32 v237, v237
    v_rcp_f32 v238, v238
    v_rcp_f32 v239, v239
    v_rcp_f32 v240, v240
    v_rcp_f32 v241, v241
    v_rcp_f32 v242, v242
    v_rcp_f32 v243, v243
    v_pk_mul_f32 v[152:153], v[152:153], v[236:237]
    v_pk_mul_f32 v[154:155], v[154:155], v[238:239]
    v_pk_mul_f32 v[156:157], v[156:157], v[240:241]
    v_pk_mul_f32 v[158:159], v[158:159], v[242:243]
    v_cvt_pk_bf16_f32 v200, v144, v145
    v_cvt_pk_bf16_f32 v201, v146, v147
    v_cvt_pk_bf16_f32 v202, v148, v149
    v_cvt_pk_bf16_f32 v203, v150, v151
    v_cvt_pk_bf16_f32 v204, v152, v153
    v_cvt_pk_bf16_f32 v205, v154, v155
    v_cvt_pk_bf16_f32 v206, v156, v157
    v_cvt_pk_bf16_f32 v207, v158, v159
    global_store_dwordx4 v8, v[200:203], s[60:61] offset:2048 sc1
    global_store_dwordx4 v8, v[204:207], s[60:61] offset:3072 sc1
    s_add_u32 s66, s80, 32
    s_lshl_b32 s66, s66, 7
    v_mov_b32 v248, s66
    global_load_dword v249, v248, s[34:35] sc1
    v_pk_mul_f32 v[236:237], v[160:161], v[160:161]
    v_pk_mul_f32 v[238:239], v[162:163], v[162:163]
    v_pk_mul_f32 v[240:241], v[164:165], v[164:165]
    v_pk_mul_f32 v[242:243], v[166:167], v[166:167]
    v_pk_fma_f32 v[236:237], v[236:237], v[228:229], v[228:229] op_sel:[0,0,1] op_sel_hi:[1,0,1]
    v_pk_fma_f32 v[238:239], v[238:239], v[228:229], v[228:229] op_sel:[0,0,1] op_sel_hi:[1,0,1]
    v_pk_fma_f32 v[240:241], v[240:241], v[228:229], v[228:229] op_sel:[0,0,1] op_sel_hi:[1,0,1]
    v_pk_fma_f32 v[242:243], v[242:243], v[228:229], v[228:229] op_sel:[0,0,1] op_sel_hi:[1,0,1]
    v_pk_mul_f32 v[236:237], v[236:237], v[160:161]
    v_pk_mul_f32 v[238:239], v[238:239], v[162:163]
    v_pk_mul_f32 v[240:241], v[240:241], v[164:165]
    v_pk_mul_f32 v[242:243], v[242:243], v[166:167]
    v_exp_f32 v236, v236
    v_exp_f32 v237, v237
    v_exp_f32 v238, v238
    v_exp_f32 v239, v239
    v_exp_f32 v240, v240
    v_exp_f32 v241, v241
    v_exp_f32 v242, v242
    v_exp_f32 v243, v243
    v_pk_fma_f32 v[236:237], v[236:237], v[230:231], v[230:231] op_sel_hi:[1,0,0]
    v_pk_fma_f32 v[238:239], v[238:239], v[230:231], v[230:231] op_sel_hi:[1,0,0]
    v_pk_fma_f32 v[240:241], v[240:241], v[230:231], v[230:231] op_sel_hi:[1,0,0]
    v_pk_fma_f32 v[242:243], v[242:243], v[230:231], v[230:231] op_sel_hi:[1,0,0]
    v_rcp_f32 v236, v236
    v_rcp_f32 v237, v237
    v_rcp_f32 v238, v238
    v_rcp_f32 v239, v239
    v_rcp_f32 v240, v240
    v_rcp_f32 v241, v241
    v_rcp_f32 v242, v242
    v_rcp_f32 v243, v243
    v_pk_mul_f32 v[160:161], v[160:161], v[236:237]
    v_pk_mul_f32 v[162:163], v[162:163], v[238:239]
    v_pk_mul_f32 v[164:165], v[164:165], v[240:241]
    v_pk_mul_f32 v[166:167], v[166:167], v[242:243]
    v_pk_mul_f32 v[236:237], v[168:169], v[168:169]
    v_pk_mul_f32 v[238:239], v[170:171], v[170:171]
    v_pk_mul_f32 v[240:241], v[172:173], v[172:173]
    v_pk_mul_f32 v[242:243], v[174:175], v[174:175]
    v_pk_fma_f32 v[236:237], v[236:237], v[228:229], v[228:229] op_sel:[0,0,1] op_sel_hi:[1,0,1]
    v_pk_fma_f32 v[238:239], v[238:239], v[228:229], v[228:229] op_sel:[0,0,1] op_sel_hi:[1,0,1]
    v_pk_fma_f32 v[240:241], v[240:241], v[228:229], v[228:229] op_sel:[0,0,1] op_sel_hi:[1,0,1]
    v_pk_fma_f32 v[242:243], v[242:243], v[228:229], v[228:229] op_sel:[0,0,1] op_sel_hi:[1,0,1]
    v_pk_mul_f32 v[236:237], v[236:237], v[168:169]
    v_pk_mul_f32 v[238:239], v[238:239], v[170:171]
    v_pk_mul_f32 v[240:241], v[240:241], v[172:173]
    v_pk_mul_f32 v[242:243], v[242:243], v[174:175]
    v_exp_f32 v236, v236
    v_exp_f32 v237, v237
    v_exp_f32 v238, v238
    v_exp_f32 v239, v239
    v_exp_f32 v240, v240
    v_exp_f32 v241, v241
    v_exp_f32 v242, v242
    v_exp_f32 v243, v243
    v_pk_fma_f32 v[236:237], v[236:237], v[230:231], v[230:231] op_sel_hi:[1,0,0]
    v_pk_fma_f32 v[238:239], v[238:239], v[230:231], v[230:231] op_sel_hi:[1,0,0]
    v_pk_fma_f32 v[240:241], v[240:241], v[230:231], v[230:231] op_sel_hi:[1,0,0]
    v_pk_fma_f32 v[242:243], v[242:243], v[230:231], v[230:231] op_sel_hi:[1,0,0]
    v_rcp_f32 v236, v236
    v_rcp_f32 v237, v237
    v_rcp_f32 v238, v238
    v_rcp_f32 v239, v239
    v_rcp_f32 v240, v240
    v_rcp_f32 v241, v241
    v_rcp_f32 v242, v242
    v_rcp_f32 v243, v243
    v_pk_mul_f32 v[168:169], v[168:169], v[236:237]
    v_pk_mul_f32 v[170:171], v[170:171], v[238:239]
    v_pk_mul_f32 v[172:173], v[172:173], v[240:241]
    v_pk_mul_f32 v[174:175], v[174:175], v[242:243]
    v_cvt_pk_bf16_f32 v192, v160, v161
    v_cvt_pk_bf16_f32 v193, v162, v163
    v_cvt_pk_bf16_f32 v194, v164, v165
    v_cvt_pk_bf16_f32 v195, v166, v167
    v_cvt_pk_bf16_f32 v196, v168, v169
    v_cvt_pk_bf16_f32 v197, v170, v171
    v_cvt_pk_bf16_f32 v198, v172, v173
    v_cvt_pk_bf16_f32 v199, v174, v175
    global_store_dwordx4 v11, v[192:195], s[60:61] offset:0 sc1
    global_store_dwordx4 v11, v[196:199], s[60:61] offset:1024 sc1
    v_pk_mul_f32 v[236:237], v[176:177], v[176:177]
    v_pk_mul_f32 v[238:239], v[178:179], v[178:179]
    v_pk_mul_f32 v[240:241], v[180:181], v[180:181]
    v_pk_mul_f32 v[242:243], v[182:183], v[182:183]
    v_pk_fma_f32 v[236:237], v[236:237], v[228:229], v[228:229] op_sel:[0,0,1] op_sel_hi:[1,0,1]
    v_pk_fma_f32 v[238:239], v[238:239], v[228:229], v[228:229] op_sel:[0,0,1] op_sel_hi:[1,0,1]
    v_pk_fma_f32 v[240:241], v[240:241], v[228:229], v[228:229] op_sel:[0,0,1] op_sel_hi:[1,0,1]
    v_pk_fma_f32 v[242:243], v[242:243], v[228:229], v[228:229] op_sel:[0,0,1] op_sel_hi:[1,0,1]
    v_pk_mul_f32 v[236:237], v[236:237], v[176:177]
    v_pk_mul_f32 v[238:239], v[238:239], v[178:179]
    v_pk_mul_f32 v[240:241], v[240:241], v[180:181]
    v_pk_mul_f32 v[242:243], v[242:243], v[182:183]
    v_exp_f32 v236, v236
    v_exp_f32 v237, v237
    v_exp_f32 v238, v238
    v_exp_f32 v239, v239
    v_exp_f32 v240, v240
    v_exp_f32 v241, v241
    v_exp_f32 v242, v242
    v_exp_f32 v243, v243
    v_pk_fma_f32 v[236:237], v[236:237], v[230:231], v[230:231] op_sel_hi:[1,0,0]
    v_pk_fma_f32 v[238:239], v[238:239], v[230:231], v[230:231] op_sel_hi:[1,0,0]
    v_pk_fma_f32 v[240:241], v[240:241], v[230:231], v[230:231] op_sel_hi:[1,0,0]
    v_pk_fma_f32 v[242:243], v[242:243], v[230:231], v[230:231] op_sel_hi:[1,0,0]
    v_rcp_f32 v236, v236
    v_rcp_f32 v237, v237
    v_rcp_f32 v238, v238
    v_rcp_f32 v239, v239
    v_rcp_f32 v240, v240
    v_rcp_f32 v241, v241
    v_rcp_f32 v242, v242
    v_rcp_f32 v243, v243
    v_pk_mul_f32 v[176:177], v[176:177], v[236:237]
    v_pk_mul_f32 v[178:179], v[178:179], v[238:239]
    v_pk_mul_f32 v[180:181], v[180:181], v[240:241]
    v_pk_mul_f32 v[182:183], v[182:183], v[242:243]
    v_pk_mul_f32 v[236:237], v[184:185], v[184:185]
    v_pk_mul_f32 v[238:239], v[186:187], v[186:187]
    v_pk_mul_f32 v[240:241], v[188:189], v[188:189]
    v_pk_mul_f32 v[242:243], v[190:191], v[190:191]
    v_pk_fma_f32 v[236:237], v[236:237], v[228:229], v[228:229] op_sel:[0,0,1] op_sel_hi:[1,0,1]
    v_pk_fma_f32 v[238:239], v[238:239], v[228:229], v[228:229] op_sel:[0,0,1] op_sel_hi:[1,0,1]
    v_pk_fma_f32 v[240:241], v[240:241], v[228:229], v[228:229] op_sel:[0,0,1] op_sel_hi:[1,0,1]
    v_pk_fma_f32 v[242:243], v[242:243], v[228:229], v[228:229] op_sel:[0,0,1] op_sel_hi:[1,0,1]
    v_pk_mul_f32 v[236:237], v[236:237], v[184:185]
    v_pk_mul_f32 v[238:239], v[238:239], v[186:187]
    v_pk_mul_f32 v[240:241], v[240:241], v[188:189]
    v_pk_mul_f32 v[242:243], v[242:243], v[190:191]
    v_exp_f32 v236, v236
    v_exp_f32 v237, v237
    v_exp_f32 v238, v238
    v_exp_f32 v239, v239
    v_exp_f32 v240, v240
    v_exp_f32 v241, v241
    v_exp_f32 v242, v242
    v_exp_f32 v243, v243
    v_pk_fma_f32 v[236:237], v[236:237], v[230:231], v[230:231] op_sel_hi:[1,0,0]
    v_pk_fma_f32 v[238:239], v[238:239], v[230:231], v[230:231] op_sel_hi:[1,0,0]
    v_pk_fma_f32 v[240:241], v[240:241], v[230:231], v[230:231] op_sel_hi:[1,0,0]
    v_pk_fma_f32 v[242:243], v[242:243], v[230:231], v[230:231] op_sel_hi:[1,0,0]
    v_rcp_f32 v236, v236
    v_rcp_f32 v237, v237
    v_rcp_f32 v238, v238
    v_rcp_f32 v239, v239
    v_rcp_f32 v240, v240
    v_rcp_f32 v241, v241
    v_rcp_f32 v242, v242
    v_rcp_f32 v243, v243
    v_pk_mul_f32 v[184:185], v[184:185], v[236:237]
    v_pk_mul_f32 v[186:187], v[186:187], v[238:239]
    v_pk_mul_f32 v[188:189], v[188:189], v[240:241]
    v_pk_mul_f32 v[190:191], v[190:191], v[242:243]
    v_cvt_pk_bf16_f32 v200, v176, v177
    v_cvt_pk_bf16_f32 v201, v178, v179
    v_cvt_pk_bf16_f32 v202, v180, v181
    v_cvt_pk_bf16_f32 v203, v182, v183
    v_cvt_pk_bf16_f32 v204, v184, v185
    v_cvt_pk_bf16_f32 v205, v186, v187
    v_cvt_pk_bf16_f32 v206, v188, v189
    v_cvt_pk_bf16_f32 v207, v190, v191
    global_store_dwordx4 v11, v[200:203], s[60:61] offset:2048 sc1
    global_store_dwordx4 v11, v[204:207], s[60:61] offset:3072 sc1
    s_lshl_b32 s66, s40, 1
    s_mul_i32 s66, s66, 114688
    s_mul_i32 s67, s3, 28672
    s_add_u32 s81, s66, s67
    s_lshr_b32 s67, s3, 1
    s_mul_i32 s67, s67, 114688
    v_lshlrev_b32 v4, 4, v1
    v_add_u32 v2, s67, v4
    s_sub_u32 s67, 114688, s67
    v_add_u32 v3, s67, v4
    s_mov_b32 s44, s60
    s_mov_b32 s45, s61
    s_mov_b32 s46, 7340032
    s_mov_b32 s47, 0x20000
    s_waitcnt vmcnt(4)
    v_cmp_ne_u32 vcc, 14, v249
    s_cbranch_vccz pfok_45
    s_mov_b32 s68, 2000000
poll_46:
    global_load_dword v247, v248, s[34:35] sc1
    s_waitcnt vmcnt(0)
    v_cmp_ne_u32 vcc, 14, v247
    s_cbranch_vccz polld_47
    s_sub_u32 s68, s68, 1
    s_cmp_lg_u32 s68, 0
    s_cbranch_scc1 poll_46
polld_47:
pfok_45:
    s_lshr_b32 s66, s3, 1
    s_and_b32 s67, s3, 1
    s_lshl_b32 s68, s40, 1
    s_add_u32 s68, s68, s66
    s_lshl_b32 s68, s68, 7
    s_lshl_b32 s69, s41, 1
    s_add_u32 s69, s69, s67
    s_lshl_b32 s76, s69, 17
    s_add_u32 s68, s68, s76
    v_lshrrev_b32 v12, 5, v1
    v_lshlrev_b32 v13, 14, v12
    v_and_b32 v14, 31, v1
    v_lshl_add_u32 v13, v14, 2, v13
    v_add_u32 v13, s68, v13
    buffer_load_dword v16, v13, s[48:51], 0 offen sc1
    v_add_u32 v14, 8192, v13
    buffer_load_dword v17, v14, s[48:51], 0 offen sc1
    v_add_u32 v13, 32768, v13
    buffer_load_dword v18, v13, s[48:51], 0 offen sc1
    v_add_u32 v14, 8192, v13
    buffer_load_dword v19, v14, s[48:51], 0 offen sc1
    v_add_u32 v13, 32768, v13
    buffer_load_dword v20, v13, s[48:51], 0 offen sc1
    v_add_u32 v14, 8192, v13
    buffer_load_dword v21, v14, s[48:51], 0 offen sc1
    v_add_u32 v13, 32768, v13
    buffer_load_dword v22, v13, s[48:51], 0 offen sc1
    v_add_u32 v14, 8192, v13
    buffer_load_dword v23, v14, s[48:51], 0 offen sc1
    s_lshl_b32 s69, s69, 6
    v_lshl_add_u32 v12, v12, 3, s69
    global_load_dwordx2 v[24:25], v12, s[28:29] offset:0
    global_load_dwordx2 v[26:27], v12, s[28:29] offset:16
    global_load_dwordx2 v[28:29], v12, s[28:29] offset:32
    global_load_dwordx2 v[30:31], v12, s[28:29] offset:48
    s_xor_b32 s66, s3, 1
    s_lshl_b32 s67, s66, 2
    s_add_u32 s67, s67, s3
    s_lshl_b32 s67, s67, 12
    v_add_u32 v225, s67, v4
    s_lshl_b32 s67, s3, 2
    s_add_u32 s67, s67, s66
    s_lshl_b32 s67, s67, 12
    v_add_u32 v229, s67, v4
    s_xor_b32 s66, s3, 2
    s_lshl_b32 s67, s66, 2
    s_add_u32 s67, s67, s3
    s_lshl_b32 s67, s67, 12
    v_add_u32 v226, s67, v4
    s_lshl_b32 s67, s3, 2
    s_add_u32 s67, s67, s66
    s_lshl_b32 s67, s67, 12
    v_add_u32 v230, s67, v4
    s_xor_b32 s66, s3, 3
    s_lshl_b32 s67, s66, 2
    s_add_u32 s67, s67, s3
    s_lshl_b32 s67, s67, 12
    v_add_u32 v227, s67, v4
    s_lshl_b32 s67, s3, 2
    s_add_u32 s67, s67, s66
    s_lshl_b32 s67, s67, 12
    v_add_u32 v231, s67, v4
    s_lshr_b32 s66, s3, 1
    s_and_b32 s67, s3, 1
    s_lshl_b32 s68, s40, 1
    s_add_u32 s68, s68, s66
    s_lshl_b32 s68, s68, 5
    v_and_b32 v6, 31, v1
    v_add_u32 v6, s68, v6
    v_mul_u32_u24 v6, 896, v6
    s_lshl_b32 s69, s41, 1
    s_add_u32 s69, s69, s67
    s_lshl_b32 s69, s69, 6
    v_lshrrev_b32 v7, 5, v1
    v_lshl_add_u32 v6, v7, 4, v6
    v_add_u32 v6, s69, v6
    s_add_u32 s82, s81, 0
    buffer_load_dwordx4 v[96:99], v2, s[44:47], s82 offen offset:0 sc1
    buffer_load_dwordx4 v[100:103], v3, s[44:47], s82 offen offset:0 sc1
    buffer_load_dwordx4 v[104:107], v2, s[44:47], s82 offen offset:1024 sc1
    buffer_load_dwordx4 v[108:111], v3, s[44:47], s82 offen offset:1024 sc1
    buffer_load_dwordx4 v[112:115], v2, s[44:47], s82 offen offset:2048 sc1
    buffer_load_dwordx4 v[116:119], v3, s[44:47], s82 offen offset:2048 sc1
    buffer_load_dwordx4 v[120:123], v2, s[44:47], s82 offen offset:3072 sc1
    buffer_load_dwordx4 v[124:127], v3, s[44:47], s82 offen offset:3072 sc1
    s_add_u32 s82, s81, 4096
    buffer_load_dwordx4 v[128:131], v2, s[44:47], s82 offen offset:0 sc1
    buffer_load_dwordx4 v[132:135], v3, s[44:47], s82 offen offset:0 sc1
    s_waitcnt vmcnt(0)
    v_max_u32 v10, v96, v100
    v_max3_u32 v10, v10, v104, v108
    v_max3_u32 v10, v10, v112, v116
    v_max3_u32 v10, v10, v120, v124
    v_max3_u32 v10, v10, v128, v132
    v_cmp_eq_u32 vcc, -1, v10
    s_cbranch_vccz h0d_49
    s_mov_b32 s68, 2000000
h0_48:
    s_add_u32 s82, s81, 0
    buffer_load_dwordx4 v[96:99], v2, s[44:47], s82 offen offset:0 sc1
    buffer_load_dwordx4 v[100:103], v3, s[44:47], s82 offen offset:0 sc1
    buffer_load_dwordx4 v[104:107], v2, s[44:47], s82 offen offset:1024 sc1
    buffer_load_dwordx4 v[108:111], v3, s[44:47], s82 offen offset:1024 sc1
    buffer_load_dwordx4 v[112:115], v2, s[44:47], s82 offen offset:2048 sc1
    buffer_load_dwordx4 v[116:119], v3, s[44:47], s82 offen offset:2048 sc1
    buffer_load_dwordx4 v[120:123], v2, s[44:47], s82 offen offset:3072 sc1
    buffer_load_dwordx4 v[124:127], v3, s[44:47], s82 offen offset:3072 sc1
    s_add_u32 s82, s81, 4096
    buffer_load_dwordx4 v[128:131], v2, s[44:47], s82 offen offset:0 sc1
    buffer_load_dwordx4 v[132:135], v3, s[44:47], s82 offen offset:0 sc1
    s_waitcnt vmcnt(0)
    v_max_u32 v10, v96, v100
    v_max3_u32 v10, v10, v104, v108
    v_max3_u32 v10, v10, v112, v116
    v_max3_u32 v10, v10, v120, v124
    v_max3_u32 v10, v10, v128, v132
    v_cmp_eq_u32 vcc, -1, v10
    s_cbranch_vccz h0d_49
    s_sub_u32 s68, s68, 1
    s_cmp_lg_u32 s68, 0
    s_cbranch_scc1 h0_48
h0d_49:
    s_waitcnt vmcnt(8)
    v_mfma_f32_32x32x16_bf16 v[32:47], a[0:3], v[96:99], 0
    v_mfma_f32_32x32x16_bf16 v[48:63], a[112:115], v[96:99], 0
    buffer_load_dwordx4 v[136:139], v2, s[44:47], s82 offen offset:1024 sc1
    buffer_load_dwordx4 v[140:143], v3, s[44:47], s82 offen offset:1024 sc1
    v_mfma_f32_32x32x16_bf16 v[64:79], a[0:3], v[100:103], 0
    v_mfma_f32_32x32x16_bf16 v[80:95], a[112:115], v[100:103], 0
    s_waitcnt vmcnt(8)
    v_mfma_f32_32x32x16_bf16 v[32:47], a[4:7], v[104:107], v[32:47]
    v_mfma_f32_32x32x16_bf16 v[48:63], a[116:119], v[104:107], v[48:63]
    buffer_load_dwordx4 v[144:147], v2, s[44:47], s82 offen offset:2048 sc1
    buffer_load_dwordx4 v[148:151], v3, s[44:47], s82 offen offset:2048 sc1
    v_mfma_f32_32x32x16_bf16 v[64:79], a[4:7], v[108:111], v[64:79]
    v_mfma_f32_32x32x16_bf16 v[80:95], a[116:119], v[108:111], v[80:95]
    s_waitcnt vmcnt(8)
    v_mfma_f32_32x32x16_bf16 v[32:47], a[8:11], v[112:115], v[32:47]
    v_mfma_f32_32x32x16_bf16 v[48:63], a[120:123], v[112:115], v[48:63]
    buffer_load_dwordx4 v[152:155], v2, s[44:47], s82 offen offset:3072 sc1
    buffer_load_dwordx4 v[156:159], v3, s[44:47], s82 offen offset:3072 sc1
    v_mfma_f32_32x32x16_bf16 v[64:79], a[8:11], v[116:119], v[64:79]
    v_mfma_f32_32x32x16_bf16 v[80:95], a[120:123], v[116:119], v[80:95]
    s_waitcnt vmcnt(6)
    v_lshlrev_b32 v232, 16, v16
    v_and_b32 v233, s72, v16
    v_lshlrev_b32 v8, 16, v24
    v_and_b32 v9, s72, v24
    v_add_f32 v232, v232, v8
    v_add_f32 v233, v233, v9
    s_waitcnt vmcnt(8)
    v_mfma_f32_32x32x16_bf16 v[32:47], a[12:15], v[120:123], v[32:47]
    v_mfma_f32_32x32x16_bf16 v[48:63], a[124:127], v[120:123], v[48:63]
    s_add_u32 s82, s81, 8192
    buffer_load_dwordx4 v[160:163], v2, s[44:47], s82 offen offset:0 sc1
    buffer_load_dwordx4 v[164:167], v3, s[44:47], s82 offen offset:0 sc1
    v_mfma_f32_32x32x16_bf16 v[64:79], a[12:15], v[124:127], v[64:79]
    v_mfma_f32_32x32x16_bf16 v[80:95], a[124:127], v[124:127], v[80:95]
    v_lshlrev_b32 v234, 16, v17
    v_and_b32 v235, s72, v17
    v_lshlrev_b32 v8, 16, v25
    v_and_b32 v9, s72, v25
    v_add_f32 v234, v234, v8
    v_add_f32 v235, v235, v9
    s_waitcnt vmcnt(8)
    v_mfma_f32_32x32x16_bf16 v[32:47], a[16:19], v[128:131], v[32:47]
    v_mfma_f32_32x32x16_bf16 v[48:63], a[128:131], v[128:131], v[48:63]
    buffer_load_dwordx4 v[168:171], v2, s[44:47], s82 offen offset:1024 sc1
    buffer_load_dwordx4 v[172:175], v3, s[44:47], s82 offen offset:1024 sc1
    v_mfma_f32_32x32x16_bf16 v[64:79], a[16:19], v[132:135], v[64:79]
    v_mfma_f32_32x32x16_bf16 v[80:95], a[128:131], v[132:135], v[80:95]
    v_lshlrev_b32 v236, 16, v18
    v_and_b32 v237, s72, v18
    v_lshlrev_b32 v8, 16, v26
    v_and_b32 v9, s72, v26
    v_add_f32 v236, v236, v8
    v_add_f32 v237, v237, v9
    s_waitcnt vmcnt(8)
    v_max_u32 v10, v136, v140
    v_cmp_eq_u32 vcc, -1, v10
    s_cbranch_vccnz L_SLOW_5
L_BACK_5:
    v_mfma_f32_32x32x16_bf16 v[32:47], a[20:23], v[136:139], v[32:47]
    v_mfma_f32_32x32x16_bf16 v[48:63], a[132:135], v[136:139], v[48:63]
    buffer_load_dwordx4 v[176:179], v2, s[44:47], s82 offen offset:2048 sc1
    buffer_load_dwordx4 v[180:183], v3, s[44:47], s82 offen offset:2048 sc1
    v_mfma_f32_32x32x16_bf16 v[64:79], a[20:23], v[140:143], v[64:79]
    v_mfma_f32_32x32x16_bf16 v[80:95], a[132:135], v[140:143], v[80:95]
    v_lshlrev_b32 v238, 16, v19
    v_and_b32 v239, s72, v19
    v_lshlrev_b32 v8, 16, v27
    v_and_b32 v9, s72, v27
    v_add_f32 v238, v238, v8
    v_add_f32 v239, v239, v9
    s_waitcnt vmcnt(8)
    v_max_u32 v10, v144, v148
    v_cmp_eq_u32 vcc, -1, v10
    s_cbranch_vccnz L_SLOW_6
L_BACK_6:
    v_mfma_f32_32x32x16_bf16 v[32:47], a[24:27], v[144:147], v[32:47]
    v_mfma_f32_32x32x16_bf16 v[48:63], a[136:139], v[144:147], v[48:63]
    buffer_load_dwordx4 v[184:187], v2, s[44:47], s82 offen offset:3072 sc1
    buffer_load_dwordx4 v[188:191], v3, s[44:47], s82 offen offset:3072 sc1
    v_mfma_f32_32x32x16_bf16 v[64:79], a[24:27], v[148:151], v[64:79]
    v_mfma_f32_32x32x16_bf16 v[80:95], a[136:139], v[148:151], v[80:95]
    v_lshlrev_b32 v240, 16, v20
    v_and_b32 v241, s72, v20
    v_lshlrev_b32 v8, 16, v28
    v_and_b32 v9, s72, v28
    v_add_f32 v240, v240, v8
    v_add_f32 v241, v241, v9
    s_waitcnt vmcnt(8)
    v_max_u32 v10, v152, v156
    v_cmp_eq_u32 vcc, -1, v10
    s_cbranch_vccnz L_SLOW_7
L_BACK_7:
    v_mfma_f32_32x32x16_bf16 v[32:47], a[28:31], v[152:155], v[32:47]
    v_mfma_f32_32x32x16_bf16 v[48:63], a[140:143], v[152:155], v[48:63]
    s_add_u32 s82, s81, 12288
    buffer_load_dwordx4 v[192:195], v2, s[44:47], s82 offen offset:0 sc1
    buffer_load_dwordx4 v[196:199], v3, s[44:47], s82 offen offset:0 sc1
    v_mfma_f32_32x32x16_bf16 v[64:79], a[28:31], v[156:159], v[64:79]
    v_mfma_f32_32x32x16_bf16 v[80:95], a[140:143], v[156:159], v[80:95]
    v_lshlrev_b32 v242, 16, v21
    v_and_b32 v243, s72, v21
    v_lshlrev_b32 v8, 16, v29
    v_and_b32 v9, s72, v29
    v_add_f32 v242, v242, v8
    v_add_f32 v243, v243, v9
    s_waitcnt vmcnt(8)
    v_max_u32 v10, v160, v164
    v_cmp_eq_u32 vcc, -1, v10
    s_cbranch_vccnz L_SLOW_8
L_BACK_8:
    v_mfma_f32_32x32x16_bf16 v[32:47], a[32:35], v[160:163], v[32:47]
    v_mfma_f32_32x32x16_bf16 v[48:63], a[144:147], v[160:163], v[48:63]
    buffer_load_dwordx4 v[200:203], v2, s[44:47], s82 offen offset:1024 sc1
    buffer_load_dwordx4 v[204:207], v3, s[44:47], s82 offen offset:1024 sc1
    v_mfma_f32_32x32x16_bf16 v[64:79], a[32:35], v[164:167], v[64:79]
    v_mfma_f32_32x32x16_bf16 v[80:95], a[144:147], v[164:167], v[80:95]
    v_lshlrev_b32 v244, 16, v22
    v_and_b32 v245, s72, v22
    v_lshlrev_b32 v8, 16, v30
    v_and_b32 v9, s72, v30
    v_add_f32 v244, v244, v8
    v_add_f32 v245, v245, v9
    s_waitcnt vmcnt(8)
    v_max_u32 v10, v168, v172
    v_cmp_eq_u32 vcc, -1, v10
    s_cbranch_vccnz L_SLOW_9
L_BACK_9:
    v_mfma_f32_32x32x16_bf16 v[32:47], a[36:39], v[168:171], v[32:47]
    v_mfma_f32_32x32x16_bf16 v[48:63], a[148:151], v[168:171], v[48:63]
    buffer_load_dwordx4 v[208:211], v2, s[44:47], s82 offen offset:2048 sc1
    buffer_load_dwordx4 v[212:215], v3, s[44:47], s82 offen offset:2048 sc1
    v_mfma_f32_32x32x16_bf16 v[64:79], a[36:39], v[172:175], v[64:79]
    v_mfma_f32_32x32x16_bf16 v[80:95], a[148:151], v[172:175], v[80:95]
    v_lshlrev_b32 v246, 16, v23
    v_and_b32 v247, s72, v23
    v_lshlrev_b32 v8, 16, v31
    v_and_b32 v9, s72, v31
    v_add_f32 v246, v246, v8
    v_add_f32 v247, v247, v9
    s_waitcnt vmcnt(8)
    v_max_u32 v10, v176, v180
    v_cmp_eq_u32 vcc, -1, v10
    s_cbranch_vccnz L_SLOW_10
L_BACK_10:
    v_mfma_f32_32x32x16_bf16 v[32:47], a[40:43], v[176:179], v[32:47]
    v_mfma_f32_32x32x16_bf16 v[48:63], a[152:155], v[176:179], v[48:63]
    buffer_load_dwordx4 v[216:219], v2, s[44:47], s82 offen offset:3072 sc1
    buffer_load_dwordx4 v[220:223], v3, s[44:47], s82 offen offset:3072 sc1
    v_mfma_f32_32x32x16_bf16 v[64:79], a[40:43], v[180:183], v[64:79]
    v_mfma_f32_32x32x16_bf16 v[80:95], a[152:155], v[180:183], v[80:95]
    s_waitcnt vmcnt(8)
    v_max_u32 v10, v184, v188
    v_cmp_eq_u32 vcc, -1, v10
    s_cbranch_vccnz L_SLOW_11
L_BACK_11:
    v_mfma_f32_32x32x16_bf16 v[32:47], a[44:47], v[184:187], v[32:47]
    v_mfma_f32_32x32x16_bf16 v[48:63], a[156:159], v[184:187], v[48:63]
    s_add_u32 s82, s81, 16384
    buffer_load_dwordx4 v[96:99], v2, s[44:47], s82 offen offset:0 sc1
    buffer_load_dwordx4 v[100:103], v3, s[44:47], s82 offen offset:0 sc1
    v_mfma_f32_32x32x16_bf16 v[64:79], a[44:47], v[188:191], v[64:79]
    v_mfma_f32_32x32x16_bf16 v[80:95], a[156:159], v[188:191], v[80:95]
    s_waitcnt vmcnt(8)
    v_max_u32 v10, v192, v196
    v_cmp_eq_u32 vcc, -1, v10
    s_cbranch_vccnz L_SLOW_12
L_BACK_12:
    v_mfma_f32_32x32x16_bf16 v[32:47], a[48:51], v[192:195], v[32:47]
    v_mfma_f32_32x32x16_bf16 v[48:63], a[160:163], v[192:195], v[48:63]
    buffer_load_dwordx4 v[104:107], v2, s[44:47], s82 offen offset:1024 sc1
    buffer_load_dwordx4 v[108:111], v3, s[44:47], s82 offen offset:1024 sc1
    v_mfma_f32_32x32x16_bf16 v[64:79], a[48:51], v[196:199], v[64:79]
    v_mfma_f32_32x32x16_bf16 v[80:95], a[160:163], v[196:199], v[80:95]
    s_waitcnt vmcnt(8)
    v_max_u32 v10, v200, v204
    v_cmp_eq_u32 vcc, -1, v10
    s_cbranch_vccnz L_SLOW_13
L_BACK_13:
    v_mfma_f32_32x32x16_bf16 v[32:47], a[52:55], v[200:203], v[32:47]
    v_mfma_f32_32x32x16_bf16 v[48:63], a[164:167], v[200:203], v[48:63]
    buffer_load_dwordx4 v[112:115], v2, s[44:47], s82 offen offset:2048 sc1
    buffer_load_dwordx4 v[116:119], v3, s[44:47], s82 offen offset:2048 sc1
    v_mfma_f32_32x32x16_bf16 v[64:79], a[52:55], v[204:207], v[64:79]
    v_mfma_f32_32x32x16_bf16 v[80:95], a[164:167], v[204:207], v[80:95]
    s_waitcnt vmcnt(8)
    v_max_u32 v10, v208, v212
    v_cmp_eq_u32 vcc, -1, v10
    s_cbranch_vccnz L_SLOW_14
L_BACK_14:
    v_mfma_f32_32x32x16_bf16 v[32:47], a[56:59], v[208:211], v[32:47]
    v_mfma_f32_32x32x16_bf16 v[48:63], a[168:171], v[208:211], v[48:63]
    buffer_load_dwordx4 v[120:123], v2, s[44:47], s82 offen offset:3072 sc1
    buffer_load_dwordx4 v[124:127], v3, s[44:47], s82 offen offset:3072 sc1
    v_mfma_f32_32x32x16_bf16 v[64:79], a[56:59], v[212:215], v[64:79]
    v_mfma_f32_32x32x16_bf16 v[80:95], a[168:171], v[212:215], v[80:95]
    s_waitcnt vmcnt(8)
    v_max_u32 v10, v216, v220
    v_cmp_eq_u32 vcc, -1, v10
    s_cbranch_vccnz L_SLOW_15
L_BACK_15:
    v_mfma_f32_32x32x16_bf16 v[32:47], a[60:63], v[216:219], v[32:47]
    v_mfma_f32_32x32x16_bf16 v[48:63], a[172:175], v[216:219], v[48:63]
    s_add_u32 s82, s81, 20480
    buffer_load_dwordx4 v[128:131], v2, s[44:47], s82 offen offset:0 sc1
    buffer_load_dwordx4 v[132:135], v3, s[44:47], s82 offen offset:0 sc1
    v_mfma_f32_32x32x16_bf16 v[64:79], a[60:63], v[220:223], v[64:79]
    v_mfma_f32_32x32x16_bf16 v[80:95], a[172:175], v[220:223], v[80:95]
    s_waitcnt vmcnt(8)
    v_max_u32 v10, v96, v100
    v_cmp_eq_u32 vcc, -1, v10
    s_cbranch_vccnz L_SLOW_16
L_BACK_16:
    v_mfma_f32_32x32x16_bf16 v[32:47], a[64:67], v[96:99], v[32:47]
    v_mfma_f32_32x32x16_bf16 v[48:63], a[176:179], v[96:99], v[48:63]
    buffer_load_dwordx4 v[136:139], v2, s[44:47], s82 offen offset:1024 sc1
    buffer_load_dwordx4 v[140:143], v3, s[44:47], s82 offen offset:1024 sc1
    v_mfma_f32_32x32x16_bf16 v[64:79], a[64:67], v[100:103], v[64:79]
    v_mfma_f32_32x32x16_bf16 v[80:95], a[176:179], v[100:103], v[80:95]
    s_waitcnt vmcnt(8)
    v_max_u32 v10, v104, v108
    v_cmp_eq_u32 vcc, -1, v10
    s_cbranch_vccnz L_SLOW_17
L_BACK_17:
    v_mfma_f32_32x32x16_bf16 v[32:47], a[68:71], v[104:107], v[32:47]
    v_mfma_f32_32x32x16_bf16 v[48:63], a[180:183], v[104:107], v[48:63]
    buffer_load_dwordx4 v[144:147], v2, s[44:47], s82 offen offset:2048 sc1
    buffer_load_dwordx4 v[148:151], v3, s[44:47], s82 offen offset:2048 sc1
    v_mfma_f32_32x32x16_bf16 v[64:79], a[68:71], v[108:111], v[64:79]
    v_mfma_f32_32x32x16_bf16 v[80:95], a[180:183], v[108:111], v[80:95]
    s_waitcnt vmcnt(8)
    v_max_u32 v10, v112, v116
    v_cmp_eq_u32 vcc, -1, v10
    s_cbranch_vccnz L_SLOW_18
L_BACK_18:
    v_mfma_f32_32x32x16_bf16 v[32:47], a[72:75], v[112:115], v[32:47]
    v_mfma_f32_32x32x16_bf16 v[48:63], a[184:187], v[112:115], v[48:63]
    buffer_load_dwordx4 v[152:155], v2, s[44:47], s82 offen offset:3072 sc1
    buffer_load_dwordx4 v[156:159], v3, s[44:47], s82 offen offset:3072 sc1
    v_mfma_f32_32x32x16_bf16 v[64:79], a[72:75], v[116:119], v[64:79]
    v_mfma_f32_32x32x16_bf16 v[80:95], a[184:187], v[116:119], v[80:95]
    s_waitcnt vmcnt(8)
    v_max_u32 v10, v120, v124
    v_cmp_eq_u32 vcc, -1, v10
    s_cbranch_vccnz L_SLOW_19
L_BACK_19:
    v_mfma_f32_32x32x16_bf16 v[32:47], a[76:79], v[120:123], v[32:47]
    v_mfma_f32_32x32x16_bf16 v[48:63], a[188:191], v[120:123], v[48:63]
    s_add_u32 s82, s81, 24576
    buffer_load_dwordx4 v[160:163], v2, s[44:47], s82 offen offset:0 sc1
    buffer_load_dwordx4 v[164:167], v3, s[44:47], s82 offen offset:0 sc1
    v_mfma_f32_32x32x16_bf16 v[64:79], a[76:79], v[124:127], v[64:79]
    v_mfma_f32_32x32x16_bf16 v[80:95], a[188:191], v[124:127], v[80:95]
    s_waitcnt vmcnt(8)
    v_max_u32 v10, v128, v132
    v_cmp_eq_u32 vcc, -1, v10
    s_cbranch_vccnz L_SLOW_20
L_BACK_20:
    v_mfma_f32_32x32x16_bf16 v[32:47], a[80:83], v[128:131], v[32:47]
    v_mfma_f32_32x32x16_bf16 v[48:63], a[192:195], v[128:131], v[48:63]
    buffer_load_dwordx4 v[168:171], v2, s[44:47], s82 offen offset:1024 sc1
    buffer_load_dwordx4 v[172:175], v3, s[44:47], s82 offen offset:1024 sc1
    v_mfma_f32_32x32x16_bf16 v[64:79], a[80:83], v[132:135], v[64:79]
    v_mfma_f32_32x32x16_bf16 v[80:95], a[192:195], v[132:135], v[80:95]
    s_waitcnt vmcnt(8)
    v_max_u32 v10, v136, v140
    v_cmp_eq_u32 vcc, -1, v10
    s_cbranch_vccnz L_SLOW_21
L_BACK_21:
    v_mfma_f32_32x32x16_bf16 v[32:47], a[84:87], v[136:139], v[32:47]
    v_mfma_f32_32x32x16_bf16 v[48:63], a[196:199], v[136:139], v[48:63]
    buffer_load_dwordx4 v[176:179], v2, s[44:47], s82 offen offset:2048 sc1
    buffer_load_dwordx4 v[180:183], v3, s[44:47], s82 offen offset:2048 sc1
    v_mfma_f32_32x32x16_bf16 v[64:79], a[84:87], v[140:143], v[64:79]
    v_mfma_f32_32x32x16_bf16 v[80:95], a[196:199], v[140:143], v[80:95]
    s_waitcnt vmcnt(8)
    v_max_u32 v10, v144, v148
    v_cmp_eq_u32 vcc, -1, v10
    s_cbranch_vccnz L_SLOW_22
L_BACK_22:
    v_mfma_f32_32x32x16_bf16 v[32:47], a[88:91], v[144:147], v[32:47]
    v_mfma_f32_32x32x16_bf16 v[48:63], a[200:203], v[144:147], v[48:63]
    buffer_load_dwordx4 v[184:187], v2, s[44:47], s82 offen offset:3072 sc1
    buffer_load_dwordx4 v[188:191], v3, s[44:47], s82 offen offset:3072 sc1
    v_mfma_f32_32x32x16_bf16 v[64:79], a[88:91], v[148:151], v[64:79]
    v_mfma_f32_32x32x16_bf16 v[80:95], a[200:203], v[148:151], v[80:95]
    s_waitcnt vmcnt(8)
    v_max_u32 v10, v152, v156
    v_cmp_eq_u32 vcc, -1, v10
    s_cbranch_vccnz L_SLOW_23
L_BACK_23:
    v_mfma_f32_32x32x16_bf16 v[32:47], a[92:95], v[152:155], v[32:47]
    v_mfma_f32_32x32x16_bf16 v[48:63], a[204:207], v[152:155], v[48:63]
    v_mfma_f32_32x32x16_bf16 v[64:79], a[92:95], v[156:159], v[64:79]
    v_mfma_f32_32x32x16_bf16 v[80:95], a[204:207], v[156:159], v[80:95]
    s_waitcnt vmcnt(6)
    v_max_u32 v10, v160, v164
    v_cmp_eq_u32 vcc, -1, v10
    s_cbranch_vccnz L_SLOW_24
L_BACK_24:
    v_mfma_f32_32x32x16_bf16 v[32:47], a[96:99], v[160:163], v[32:47]
    v_mfma_f32_32x32x16_bf16 v[48:63], a[208:211], v[160:163], v[48:63]
    v_mfma_f32_32x32x16_bf16 v[64:79], a[96:99], v[164:167], v[64:79]
    v_mfma_f32_32x32x16_bf16 v[80:95], a[208:211], v[164:167], v[80:95]
    s_waitcnt vmcnt(4)
    v_max_u32 v10, v168, v172
    v_cmp_eq_u32 vcc, -1, v10
    s_cbranch_vccnz L_SLOW_25
L_BACK_25:
    v_mfma_f32_32x32x16_bf16 v[32:47], a[100:103], v[168:171], v[32:47]
    v_mfma_f32_32x32x16_bf16 v[48:63], a[212:215], v[168:171], v[48:63]
    v_mfma_f32_32x32x16_bf16 v[64:79], a[100:103], v[172:175], v[64:79]
    v_mfma_f32_32x32x16_bf16 v[80:95], a[212:215], v[172:175], v[80:95]
    s_waitcnt vmcnt(2)
    v_max_u32 v10, v176, v180
    v_cmp_eq_u32 vcc, -1, v10
    s_cbranch_vccnz L_SLOW_26
L_BACK_26:
    v_mfma_f32_32x32x16_bf16 v[32:47], a[104:107], v[176:179], v[32:47]
    v_mfma_f32_32x32x16_bf16 v[48:63], a[216:219], v[176:179], v[48:63]
    v_mfma_f32_32x32x16_bf16 v[64:79], a[104:107], v[180:183], v[64:79]
    v_mfma_f32_32x32x16_bf16 v[80:95], a[216:219], v[180:183], v[80:95]
    s_waitcnt vmcnt(0)
    v_max_u32 v10, v184, v188
    v_cmp_eq_u32 vcc, -1, v10
    s_cbranch_vccnz L_SLOW_27
L_BACK_27:
    v_mfma_f32_32x32x16_bf16 v[32:47], a[108:111], v[184:187], v[32:47]
    v_mfma_f32_32x32x16_bf16 v[48:63], a[220:223], v[184:187], v[48:63]
    v_mfma_f32_32x32x16_bf16 v[64:79], a[108:111], v[188:191], v[64:79]
    v_mfma_f32_32x32x16_bf16 v[80:95], a[220:223], v[188:191], v[80:95]
    s_nop 10
    ds_write_b128 v225, v[48:51] offset:0
    ds_write_b128 v225, v[52:55] offset:1024
    ds_write_b128 v225, v[56:59] offset:2048
    ds_write_b128 v225, v[60:63] offset:3072
    ds_write_b128 v226, v[64:67] offset:0
    ds_write_b128 v226, v[68:71] offset:1024
    ds_write_b128 v226, v[72:75] offset:2048
    ds_write_b128 v226, v[76:79] offset:3072
    ds_write_b128 v227, v[80:83] offset:0
    ds_write_b128 v227, v[84:87] offset:1024
    ds_write_b128 v227, v[88:91] offset:2048
    ds_write_b128 v227, v[92:95] offset:3072
    v_pk_add_f32 v[32:33], v[32:33], v[232:233]
    v_pk_add_f32 v[34:35], v[34:35], v[234:235]
    v_pk_add_f32 v[36:37], v[36:37], v[236:237]
    v_pk_add_f32 v[38:39], v[38:39], v[238:239]
    v_pk_add_f32 v[40:41], v[40:41], v[240:241]
    v_pk_add_f32 v[42:43], v[42:43], v[242:243]
    v_pk_add_f32 v[44:45], v[44:45], v[244:245]
    v_pk_add_f32 v[46:47], v[46:47], v[246:247]
    s_waitcnt lgkmcnt(0)
    s_barrier
    ds_read_b128 v[96:99], v229 offset:0
    ds_read_b128 v[100:103], v229 offset:1024
    ds_read_b128 v[104:107], v229 offset:2048
    ds_read_b128 v[108:111], v229 offset:3072
    ds_read_b128 v[112:115], v230 offset:0
    ds_read_b128 v[116:119], v230 offset:1024
    ds_read_b128 v[120:123], v230 offset:2048
    ds_read_b128 v[124:127], v230 offset:3072
    ds_read_b128 v[128:131], v231 offset:0
    ds_read_b128 v[132:135], v231 offset:1024
    ds_read_b128 v[136:139], v231 offset:2048
    ds_read_b128 v[140:143], v231 offset:3072
    s_waitcnt lgkmcnt(8)
    v_pk_add_f32 v[32:33], v[32:33], v[96:97]
    v_pk_add_f32 v[34:35], v[34:35], v[98:99]
    v_pk_add_f32 v[36:37], v[36:37], v[100:101]
    v_pk_add_f32 v[38:39], v[38:39], v[102:103]
    v_pk_add_f32 v[40:41], v[40:41], v[104:105]
    v_pk_add_f32 v[42:43], v[42:43], v[106:107]
    v_pk_add_f32 v[44:45], v[44:45], v[108:109]
    v_pk_add_f32 v[46:47], v[46:47], v[110:111]
    s_waitcnt lgkmcnt(4)
    v_pk_add_f32 v[32:33], v[32:33], v[112:113]
    v_pk_add_f32 v[34:35], v[34:35], v[114:115]
    v_pk_add_f32 v[36:37], v[36:37], v[116:117]
    v_pk_add_f32 v[38:39], v[38:39], v[118:119]
    v_pk_add_f32 v[40:41], v[40:41], v[120:121]
    v_pk_add_f32 v[42:43], v[42:43], v[122:123]
    v_pk_add_f32 v[44:45], v[44:45], v[124:125]
    v_pk_add_f32 v[46:47], v[46:47], v[126:127]
    s_waitcnt lgkmcnt(0)
    v_pk_add_f32 v[32:33], v[32:33], v[128:129]
    v_pk_add_f32 v[34:35], v[34:35], v[130:131]
    v_pk_add_f32 v[36:37], v[36:37], v[132:133]
    v_pk_add_f32 v[38:39], v[38:39], v[134:135]
    v_pk_add_f32 v[40:41], v[40:41], v[136:137]
    v_pk_add_f32 v[42:43], v[42:43], v[138:139]
    v_pk_add_f32 v[44:45], v[44:45], v[140:141]
    v_pk_add_f32 v[46:47], v[46:47], v[142:143]
    v_cvt_pk_bf16_f32 v192, v32, v33
    v_cvt_pk_bf16_f32 v193, v34, v35
    v_cvt_pk_bf16_f32 v194, v36, v37
    v_cvt_pk_bf16_f32 v195, v38, v39
    v_cvt_pk_bf16_f32 v196, v40, v41
    v_cvt_pk_bf16_f32 v197, v42, v43
    v_cvt_pk_bf16_f32 v198, v44, v45
    v_cvt_pk_bf16_f32 v199, v46, v47
    s_nop 1
    v_permlane32_swap_b32 v192, v194
    v_permlane32_swap_b32 v193, v195
    v_permlane32_swap_b32 v196, v198
    v_permlane32_swap_b32 v197, v199
    s_nop 1
    global_store_dwordx4 v6, v[192:195], s[30:31]
    global_store_dwordx4 v6, v[196:199], s[30:31] offset:32
    s_branch L_END
L_SLOW_5:
    s_mov_b32 s68, 2000000
    s_add_u32 s83, s81, 4096
L_SLOWL_5:
    buffer_load_dwordx4 v[136:139], v2, s[44:47], s83 offen offset:1024 sc1
    buffer_load_dwordx4 v[140:143], v3, s[44:47], s83 offen offset:1024 sc1
    s_waitcnt vmcnt(0)
    v_max_u32 v10, v136, v140
    v_cmp_eq_u32 vcc, -1, v10
    s_cbranch_vccz L_BACK_5
    s_sub_u32 s68, s68, 1
    s_cmp_lg_u32 s68, 0
    s_cbranch_scc1 L_SLOWL_5
    s_branch L_BACK_5
L_SLOW_6:
    s_mov_b32 s68, 2000000
    s_add_u32 s83, s81, 4096
L_SLOWL_6:
    buffer_load_dwordx4 v[144:147], v2, s[44:47], s83 offen offset:2048 sc1
    buffer_load_dwordx4 v[148:151], v3, s[44:47], s83 offen offset:2048 sc1
    s_waitcnt vmcnt(0)
    v_max_u32 v10, v144, v148
    v_cmp_eq_u32 vcc, -1, v10
    s_cbranch_vccz L_BACK_6
    s_sub_u32 s68, s68, 1
    s_cmp_lg_u32 s68, 0
    s_cbranch_scc1 L_SLOWL_6
    s_branch L_BACK_6
L_SLOW_7:
    s_mov_b32 s68, 2000000
    s_add_u32 s83, s81, 4096
L_SLOWL_7:
    buffer_load_dwordx4 v[152:155], v2, s[44:47], s83 offen offset:3072 sc1
    buffer_load_dwordx4 v[156:159], v3, s[44:47], s83 offen offset:3072 sc1
    s_waitcnt vmcnt(0)
    v_max_u32 v10, v152, v156
    v_cmp_eq_u32 vcc, -1, v10
    s_cbranch_vccz L_BACK_7
    s_sub_u32 s68, s68, 1
    s_cmp_lg_u32 s68, 0
    s_cbranch_scc1 L_SLOWL_7
    s_branch L_BACK_7
L_SLOW_8:
    s_mov_b32 s68, 2000000
    s_add_u32 s83, s81, 8192
L_SLOWL_8:
    buffer_load_dwordx4 v[160:163], v2, s[44:47], s83 offen offset:0 sc1
    buffer_load_dwordx4 v[164:167], v3, s[44:47], s83 offen offset:0 sc1
    s_waitcnt vmcnt(0)
    v_max_u32 v10, v160, v164
    v_cmp_eq_u32 vcc, -1, v10
    s_cbranch_vccz L_BACK_8
    s_sub_u32 s68, s68, 1
    s_cmp_lg_u32 s68, 0
    s_cbranch_scc1 L_SLOWL_8
    s_branch L_BACK_8
L_SLOW_9:
    s_mov_b32 s68, 2000000
    s_add_u32 s83, s81, 8192
L_SLOWL_9:
    buffer_load_dwordx4 v[168:171], v2, s[44:47], s83 offen offset:1024 sc1
    buffer_load_dwordx4 v[172:175], v3, s[44:47], s83 offen offset:1024 sc1
    s_waitcnt vmcnt(0)
    v_max_u32 v10, v168, v172
    v_cmp_eq_u32 vcc, -1, v10
    s_cbranch_vccz L_BACK_9
    s_sub_u32 s68, s68, 1
    s_cmp_lg_u32 s68, 0
    s_cbranch_scc1 L_SLOWL_9
    s_branch L_BACK_9
L_SLOW_10:
    s_mov_b32 s68, 2000000
    s_add_u32 s83, s81, 8192
L_SLOWL_10:
    buffer_load_dwordx4 v[176:179], v2, s[44:47], s83 offen offset:2048 sc1
    buffer_load_dwordx4 v[180:183], v3, s[44:47], s83 offen offset:2048 sc1
    s_waitcnt vmcnt(0)
    v_max_u32 v10, v176, v180
    v_cmp_eq_u32 vcc, -1, v10
    s_cbranch_vccz L_BACK_10
    s_sub_u32 s68, s68, 1
    s_cmp_lg_u32 s68, 0
    s_cbranch_scc1 L_SLOWL_10
    s_branch L_BACK_10
L_SLOW_11:
    s_mov_b32 s68, 2000000
    s_add_u32 s83, s81, 8192
L_SLOWL_11:
    buffer_load_dwordx4 v[184:187], v2, s[44:47], s83 offen offset:3072 sc1
    buffer_load_dwordx4 v[188:191], v3, s[44:47], s83 offen offset:3072 sc1
    s_waitcnt vmcnt(0)
    v_max_u32 v10, v184, v188
    v_cmp_eq_u32 vcc, -1, v10
    s_cbranch_vccz L_BACK_11
    s_sub_u32 s68, s68, 1
    s_cmp_lg_u32 s68, 0
    s_cbranch_scc1 L_SLOWL_11
    s_branch L_BACK_11
L_SLOW_12:
    s_mov_b32 s68, 2000000
    s_add_u32 s83, s81, 12288
L_SLOWL_12:
    buffer_load_dwordx4 v[192:195], v2, s[44:47], s83 offen offset:0 sc1
    buffer_load_dwordx4 v[196:199], v3, s[44:47], s83 offen offset:0 sc1
    s_waitcnt vmcnt(0)
    v_max_u32 v10, v192, v196
    v_cmp_eq_u32 vcc, -1, v10
    s_cbranch_vccz L_BACK_12
    s_sub_u32 s68, s68, 1
    s_cmp_lg_u32 s68, 0
    s_cbranch_scc1 L_SLOWL_12
    s_branch L_BACK_12
L_SLOW_13:
    s_mov_b32 s68, 2000000
    s_add_u32 s83, s81, 12288
L_SLOWL_13:
    buffer_load_dwordx4 v[200:203], v2, s[44:47], s83 offen offset:1024 sc1
    buffer_load_dwordx4 v[204:207], v3, s[44:47], s83 offen offset:1024 sc1
    s_waitcnt vmcnt(0)
    v_max_u32 v10, v200, v204
    v_cmp_eq_u32 vcc, -1, v10
    s_cbranch_vccz L_BACK_13
    s_sub_u32 s68, s68, 1
    s_cmp_lg_u32 s68, 0
    s_cbranch_scc1 L_SLOWL_13
    s_branch L_BACK_13
L_SLOW_14:
    s_mov_b32 s68, 2000000
    s_add_u32 s83, s81, 12288
L_SLOWL_14:
    buffer_load_dwordx4 v[208:211], v2, s[44:47], s83 offen offset:2048 sc1
    buffer_load_dwordx4 v[212:215], v3, s[44:47], s83 offen offset:2048 sc1
    s_waitcnt vmcnt(0)
    v_max_u32 v10, v208, v212
    v_cmp_eq_u32 vcc, -1, v10
    s_cbranch_vccz L_BACK_14
    s_sub_u32 s68, s68, 1
    s_cmp_lg_u32 s68, 0
    s_cbranch_scc1 L_SLOWL_14
    s_branch L_BACK_14
L_SLOW_15:
    s_mov_b32 s68, 2000000
    s_add_u32 s83, s81, 12288
L_SLOWL_15:
    buffer_load_dwordx4 v[216:219], v2, s[44:47], s83 offen offset:3072 sc1
    buffer_load_dwordx4 v[220:223], v3, s[44:47], s83 offen offset:3072 sc1
    s_waitcnt vmcnt(0)
    v_max_u32 v10, v216, v220
    v_cmp_eq_u32 vcc, -1, v10
    s_cbranch_vccz L_BACK_15
    s_sub_u32 s68, s68, 1
    s_cmp_lg_u32 s68, 0
    s_cbranch_scc1 L_SLOWL_15
    s_branch L_BACK_15
L_SLOW_16:
    s_mov_b32 s68, 2000000
    s_add_u32 s83, s81, 16384
L_SLOWL_16:
    buffer_load_dwordx4 v[96:99], v2, s[44:47], s83 offen offset:0 sc1
    buffer_load_dwordx4 v[100:103], v3, s[44:47], s83 offen offset:0 sc1
    s_waitcnt vmcnt(0)
    v_max_u32 v10, v96, v100
    v_cmp_eq_u32 vcc, -1, v10
    s_cbranch_vccz L_BACK_16
    s_sub_u32 s68, s68, 1
    s_cmp_lg_u32 s68, 0
    s_cbranch_scc1 L_SLOWL_16
    s_branch L_BACK_16
L_SLOW_17:
    s_mov_b32 s68, 2000000
    s_add_u32 s83, s81, 16384
L_SLOWL_17:
    buffer_load_dwordx4 v[104:107], v2, s[44:47], s83 offen offset:1024 sc1
    buffer_load_dwordx4 v[108:111], v3, s[44:47], s83 offen offset:1024 sc1
    s_waitcnt vmcnt(0)
    v_max_u32 v10, v104, v108
    v_cmp_eq_u32 vcc, -1, v10
    s_cbranch_vccz L_BACK_17
    s_sub_u32 s68, s68, 1
    s_cmp_lg_u32 s68, 0
    s_cbranch_scc1 L_SLOWL_17
    s_branch L_BACK_17
L_SLOW_18:
    s_mov_b32 s68, 2000000
    s_add_u32 s83, s81, 16384
L_SLOWL_18:
    buffer_load_dwordx4 v[112:115], v2, s[44:47], s83 offen offset:2048 sc1
    buffer_load_dwordx4 v[116:119], v3, s[44:47], s83 offen offset:2048 sc1
    s_waitcnt vmcnt(0)
    v_max_u32 v10, v112, v116
    v_cmp_eq_u32 vcc, -1, v10
    s_cbranch_vccz L_BACK_18
    s_sub_u32 s68, s68, 1
    s_cmp_lg_u32 s68, 0
    s_cbranch_scc1 L_SLOWL_18
    s_branch L_BACK_18
L_SLOW_19:
    s_mov_b32 s68, 2000000
    s_add_u32 s83, s81, 16384
L_SLOWL_19:
    buffer_load_dwordx4 v[120:123], v2, s[44:47], s83 offen offset:3072 sc1
    buffer_load_dwordx4 v[124:127], v3, s[44:47], s83 offen offset:3072 sc1
    s_waitcnt vmcnt(0)
    v_max_u32 v10, v120, v124
    v_cmp_eq_u32 vcc, -1, v10
    s_cbranch_vccz L_BACK_19
    s_sub_u32 s68, s68, 1
    s_cmp_lg_u32 s68, 0
    s_cbranch_scc1 L_SLOWL_19
    s_branch L_BACK_19
L_SLOW_20:
    s_mov_b32 s68, 2000000
    s_add_u32 s83, s81, 20480
L_SLOWL_20:
    buffer_load_dwordx4 v[128:131], v2, s[44:47], s83 offen offset:0 sc1
    buffer_load_dwordx4 v[132:135], v3, s[44:47], s83 offen offset:0 sc1
    s_waitcnt vmcnt(0)
    v_max_u32 v10, v128, v132
    v_cmp_eq_u32 vcc, -1, v10
    s_cbranch_vccz L_BACK_20
    s_sub_u32 s68, s68, 1
    s_cmp_lg_u32 s68, 0
    s_cbranch_scc1 L_SLOWL_20
    s_branch L_BACK_20
L_SLOW_21:
    s_mov_b32 s68, 2000000
    s_add_u32 s83, s81, 20480
L_SLOWL_21:
    buffer_load_dwordx4 v[136:139], v2, s[44:47], s83 offen offset:1024 sc1
    buffer_load_dwordx4 v[140:143], v3, s[44:47], s83 offen offset:1024 sc1
    s_waitcnt vmcnt(0)
    v_max_u32 v10, v136, v140
    v_cmp_eq_u32 vcc, -1, v10
    s_cbranch_vccz L_BACK_21
    s_sub_u32 s68, s68, 1
    s_cmp_lg_u32 s68, 0
    s_cbranch_scc1 L_SLOWL_21
    s_branch L_BACK_21
L_SLOW_22:
    s_mov_b32 s68, 2000000
    s_add_u32 s83, s81, 20480
L_SLOWL_22:
    buffer_load_dwordx4 v[144:147], v2, s[44:47], s83 offen offset:2048 sc1
    buffer_load_dwordx4 v[148:151], v3, s[44:47], s83 offen offset:2048 sc1
    s_waitcnt vmcnt(0)
    v_max_u32 v10, v144, v148
    v_cmp_eq_u32 vcc, -1, v10
    s_cbranch_vccz L_BACK_22
    s_sub_u32 s68, s68, 1
    s_cmp_lg_u32 s68, 0
    s_cbranch_scc1 L_SLOWL_22
    s_branch L_BACK_22
L_SLOW_23:
    s_mov_b32 s68, 2000000
    s_add_u32 s83, s81, 20480
L_SLOWL_23:
    buffer_load_dwordx4 v[152:155], v2, s[44:47], s83 offen offset:3072 sc1
    buffer_load_dwordx4 v[156:159], v3, s[44:47], s83 offen offset:3072 sc1
    s_waitcnt vmcnt(0)
    v_max_u32 v10, v152, v156
    v_cmp_eq_u32 vcc, -1, v10
    s_cbranch_vccz L_BACK_23
    s_sub_u32 s68, s68, 1
    s_cmp_lg_u32 s68, 0
    s_cbranch_scc1 L_SLOWL_23
    s_branch L_BACK_23
L_SLOW_24:
    s_mov_b32 s68, 2000000
    s_add_u32 s83, s81, 24576
L_SLOWL_24:
    buffer_load_dwordx4 v[160:163], v2, s[44:47], s83 offen offset:0 sc1
    buffer_load_dwordx4 v[164:167], v3, s[44:47], s83 offen offset:0 sc1
    s_waitcnt vmcnt(0)
    v_max_u32 v10, v160, v164
    v_cmp_eq_u32 vcc, -1, v10
    s_cbranch_vccz L_BACK_24
    s_sub_u32 s68, s68, 1
    s_cmp_lg_u32 s68, 0
    s_cbranch_scc1 L_SLOWL_24
    s_branch L_BACK_24
L_SLOW_25:
    s_mov_b32 s68, 2000000
    s_add_u32 s83, s81, 24576
L_SLOWL_25:
    buffer_load_dwordx4 v[168:171], v2, s[44:47], s83 offen offset:1024 sc1
    buffer_load_dwordx4 v[172:175], v3, s[44:47], s83 offen offset:1024 sc1
    s_waitcnt vmcnt(0)
    v_max_u32 v10, v168, v172
    v_cmp_eq_u32 vcc, -1, v10
    s_cbranch_vccz L_BACK_25
    s_sub_u32 s68, s68, 1
    s_cmp_lg_u32 s68, 0
    s_cbranch_scc1 L_SLOWL_25
    s_branch L_BACK_25
L_SLOW_26:
    s_mov_b32 s68, 2000000
    s_add_u32 s83, s81, 24576
L_SLOWL_26:
    buffer_load_dwordx4 v[176:179], v2, s[44:47], s83 offen offset:2048 sc1
    buffer_load_dwordx4 v[180:183], v3, s[44:47], s83 offen offset:2048 sc1
    s_waitcnt vmcnt(0)
    v_max_u32 v10, v176, v180
    v_cmp_eq_u32 vcc, -1, v10
    s_cbranch_vccz L_BACK_26
    s_sub_u32 s68, s68, 1
    s_cmp_lg_u32 s68, 0
    s_cbranch_scc1 L_SLOWL_26
    s_branch L_BACK_26
L_SLOW_27:
    s_mov_b32 s68, 2000000
    s_add_u32 s83, s81, 24576
L_SLOWL_27:
    buffer_load_dwordx4 v[184:187], v2, s[44:47], s83 offen offset:3072 sc1
    buffer_load_dwordx4 v[188:191], v3, s[44:47], s83 offen offset:3072 sc1
    s_waitcnt vmcnt(0)
    v_max_u32 v10, v184, v188
    v_cmp_eq_u32 vcc, -1, v10
    s_cbranch_vccz L_BACK_27
    s_sub_u32 s68, s68, 1
    s_cmp_lg_u32 s68, 0
    s_cbranch_scc1 L_SLOWL_27
    s_branch L_BACK_27
L_OTHER:
    s_cmp_ge_u32 s2, 233
    s_cbranch_scc1 L_END
    v_and_b32 v1, 63, v0
    v_lshrrev_b32 v2, 6, v0
    s_nop 0
    v_readfirstlane_b32 s3, v2
    s_waitcnt lgkmcnt(0)
    s_cmp_lg_u32 s2, 224
    s_cbranch_scc1 L_PREF
    v_mov_b32 v4, 0
    v_mov_b32 v5, 0
    v_mov_b32 v6, 0
    v_mov_b32 v7, 0
    v_lshlrev_b32 v2, 4, v0
    global_store_dwordx4 v2, v[4:7], s[34:35] sc1
    v_add_u32 v3, 4096, v2
    global_store_dwordx4 v3, v[4:7], s[34:35] sc1
    s_waitcnt vmcnt(0)
    s_barrier
    s_cmp_lg_u32 s3, 0
    s_cbranch_scc1 L_END
    v_mov_b32 v2, 0
    v_mov_b32 v3, 1
    s_mov_b64 exec, 1
    global_store_dword v2, v3, s[32:33] sc1
    s_branch L_END
L_PREF:
    v_min_u32 v2, 8, v1
    v_lshlrev_b32 v2, 21, v2
    v_add_u32 v2, 1048576, v2
    global_load_dword v8, v2, s[34:35]
    v_mov_b32 v3, 0
    global_load_dword v9, v3, s[30:31]
    global_load_dword v10, v3, s[22:23]
    global_load_dword v11, v3, s[26:27]
    global_load_dword v12, v3, s[16:17]
    global_load_dword v13, v3, s[24:25]
    global_load_dword v14, v3, s[28:29]
    global_load_dword v15, v3, s[18:19]
    global_load_dword v16, v3, s[34:35]
    s_waitcnt vmcnt(0)
L_END:
    s_endpgm
L_CODE_END:
.section .rodata,"a"
.p2align 6
.amdhsa_kernel sequential_preLN__ssm_conv_h3__dense_activation_gelu__prompt_kernel
  .amdhsa_next_free_vgpr 512
  .amdhsa_next_free_sgpr 100
  .amdhsa_accum_offset 256
  .amdhsa_group_segment_fixed_size 0
  .amdhsa_kernarg_size 112
  .amdhsa_user_sgpr_count 2
  .amdhsa_user_sgpr_kernarg_segment_ptr 1
  .amdhsa_system_sgpr_workgroup_id_x 1
  .amdhsa_float_denorm_mode_32 3
.end_amdhsa_kernel
```
